```python
import torch

def _softmax(x, axis=-1):
    return torch.softmax(x, dim=axis)
def _gelu(x):
    return torch.nn.functional.gelu(x, approximate="tanh")
def _silu(x):
    return torch.nn.functional.silu(x)
def _sigmoid(x):
    return torch.sigmoid(x)
def _layernorm(x, axis=-1, eps=1e-5):
    m = x.mean(dim=axis, keepdim=True)
    v = x.var(dim=axis, keepdim=True, unbiased=False)
    return (x - m) / torch.sqrt(v + eps)
def _scatter_add(tgt, idx, src, axis=0):
    return tgt.clone().index_add_(axis, idx, src)
def _segment_sum(src, seg, n):
    out = torch.zeros((n,) + src.shape[1:], dtype=src.dtype)
    return out.index_add_(0, seg, src)
def _pad(x, pw):
    flat = tuple(v for pair in reversed(pw) for v in pair)
    return torch.nn.functional.pad(x, flat)

kernel_name = 'gated_mix__spectral_fnet__geglu_ffn__prompt'

def setup_inputs():

    _w = (lambda a: (lambda t: t.to(torch.bfloat16) if t.is_floating_point() else t)(torch.as_tensor(a)))
    def _A_setup():
        B, S, D = 1, 2048, 1024
        ns = torch.arange(S)[:, None] * torch.arange(S)[None, :]
        nd = torch.arange(D)[:, None] * torch.arange(D)[None, :]
        Ws_re = torch.cos(-2.0 * torch.pi * ns / S).to(float)
        Ws_im = torch.sin(-2.0 * torch.pi * ns / S).to(float)
        Wd_re = torch.cos(-2.0 * torch.pi * nd / D).to(float)
        Wd_im = torch.sin(-2.0 * torch.pi * nd / D).to(float)
        return {
            "x": _w((lambda *s: torch.randn(*s, dtype=torch.bfloat16) * 0.05)(B, S, D)),
            "dft_seq_re": _w(Ws_re),
            "dft_seq_im": _w(Ws_im),
            "dft_hid_re": _w(Wd_re),
            "dft_hid_im": _w(Wd_im),
        }
    _A_in = _A_setup()

    def _B_setup():
        B, S, D, F = 1, 2048, 1024, 3584
        return {
            "x": _w((lambda *s: torch.randn(*s, dtype=torch.bfloat16) * 0.05)(B, S, D)),
            "w_gate": _w((lambda *s: torch.randn(*s, dtype=torch.bfloat16) * 0.4)(D, F)),
            "w_up": _w((lambda *s: torch.randn(*s, dtype=torch.bfloat16) * 0.4)(D, F)),
            "w_down": _w((lambda *s: torch.randn(*s, dtype=torch.bfloat16) * 0.4)(F, D)),
        }
    _B_in = _B_setup()

    return {
        "A_x": _A_in["x"],
        "A_dft_seq_re": _A_in["dft_seq_re"],
        "A_dft_seq_im": _A_in["dft_seq_im"],
        "A_dft_hid_re": _A_in["dft_hid_re"],
        "A_dft_hid_im": _A_in["dft_hid_im"],
        "B_x": _B_in["x"],
        "B_w_gate": _B_in["w_gate"],
        "B_w_up": _B_in["w_up"],
        "B_w_down": _B_in["w_down"],
        "gate_w": _w((lambda *s: torch.randn(*s, dtype=torch.bfloat16) * 0.05)(1024) * 16.0),
    }

def reference(A_x, A_dft_seq_re, A_dft_seq_im, A_dft_hid_re, A_dft_hid_im, B_x, B_w_gate, B_w_up, B_w_down, gate_w):
    def _A_ref(x, dft_seq_re, dft_seq_im, dft_hid_re, dft_hid_im):
        a = torch.einsum("bsd,ed->bse", x, dft_hid_re)
        b = torch.einsum("bsd,ed->bse", x, dft_hid_im)
        y = torch.einsum("ts,bse->bte", dft_seq_re, a) - torch.einsum("ts,bse->bte", dft_seq_im, b)
        return y

    def _B_ref(x, w_gate, w_up, w_down):
        return (_gelu(x @ w_gate) * (x @ w_up)) @ w_down

    x = A_x
    g = _sigmoid((x * gate_w).sum(-1, keepdims=True))
    a = _A_ref(x, A_dft_seq_re, A_dft_seq_im, A_dft_hid_re, A_dft_hid_im)
    b = _B_ref(x, B_w_gate, B_w_up, B_w_down)
    return g * a + (1 - g) * b
```

```asm
; @launch grid=(256,1,1) block=(512,1,1) lds=163840
.amdgcn_target "amdgcn-amd-amdhsa--gfx950"
.text
    .globl gated_mix__spectral_fnet__geglu_ffn__prompt_kernel
    .p2align 8
    .type gated_mix__spectral_fnet__geglu_ffn__prompt_kernel,@function
gated_mix__spectral_fnet__geglu_ffn__prompt_kernel:
    s_cmp_ge_u32 s2, 256
    s_cbranch_scc1 L_p1_end
    s_load_dwordx2 s[4:5], s[0:1], 0
    s_load_dwordx4 s[12:15], s[0:1], 48
    s_load_dwordx4 s[20:23], s[0:1], 64
    s_load_dwordx2 s[18:19], s[0:1], 96
    s_load_dwordx2 s[8:9], s[0:1], 80
    v_lshrrev_b32 v1, 6, v0
    v_and_b32 v2, 63, v0
    s_nop 0
    v_readfirstlane_b32 s48, v1
    s_and_b32 s60, s2, 7
    s_lshr_b32 s61, s2, 3
    s_and_b32 s62, s60, 4
    s_and_b32 s63, s61, 3
    s_add_u32 s49, s62, s63
    s_and_b32 s62, s60, 3
    s_lshl_b32 s62, s62, 3
    s_lshr_b32 s63, s61, 2
    s_add_u32 s50, s62, s63
    v_lshlrev_b32 v3, 4, v2
    s_lshl_b32 s66, s48, 12
    s_add_u32 s59, s66, 65536
    s_mov_b32 s56, s66
    s_mov_b32 s57, 65536
    s_mov_b32 s58, 0
    s_lshr_b32 s63, s2, 6
    s_lshl_b32 s63, s63, 2
    s_and_b32 s62, s48, 1
    s_lshl_b32 s62, s62, 1
    s_add_u32 s63, s63, s62
    s_and_b32 s62, s48, 2
    s_lshl_b32 s62, s62, 3
    s_add_u32 s62, s62, s63
    s_lshl_b32 s62, s62, 6
    s_and_b32 s63, s2, 63
    s_add_u32 s70, s62, s63
    s_lshl_b32 s63, s70, 11
    s_add_u32 s64, s63, 131072
    s_lshl_b32 s68, s48, 11
    s_add_u32 s68, s68, 131072
    s_cmp_lt_u32 s48, 4
    s_cbranch_scc1 L_p1_fft
    s_lshl_b32 s66, s49, 8
    s_lshl_b32 s67, s48, 5
    s_add_u32 s66, s66, s67
    s_lshl_b32 s66, s66, 11
    v_lshrrev_b32 v4, 3, v2
    v_lshlrev_b32 v4, 11, v4
    v_add_u32 v4, s66, v4
    v_and_b32 v5, 7, v2
    v_lshrrev_b32 v6, 4, v2
    v_xor_b32 v5, v5, v6
    v_lshlrev_b32 v5, 4, v5
    v_add_u32 v122, v4, v5
    v_xor_b32 v5, 64, v5
    v_add_u32 v4, v4, v5
    v_add_u32 v123, 15360, v4
    v_add_u32 v124, 30720, v122
    v_add_u32 v125, 30720, v123
    s_lshl_b32 s66, s48, 3
    v_add_u32 v5, s66, v6
    v_mul_u32_u24 v5, 7168, v5
    s_and_b32 s66, s48, 1
    s_lshl_b32 s66, s66, 1
    s_mul_i32 s65, s50, 224
    v_lshlrev_b32 v4, 2, v6
    v_and_b32 v6, 15, v2
    v_xor_b32 v4, v4, v6
    v_xor_b32 v4, s66, v4
    v_cmp_gt_u32 vcc, 14, v4
    v_lshlrev_b32 v4, 4, v4
    v_add_u32 v5, v5, v4
    v_add_u32 v5, s65, v5
    v_mov_b32 v4, 0x7f000000
    v_cndmask_b32 v126, v4, v5, vcc
    v_add_u32 v127, 27648, v126
    v_subrev_u32 v16, 262144, v122
    v_subrev_u32 v17, 262144, v123
    v_subrev_u32 v18, 262144, v124
    v_subrev_u32 v19, 262144, v125
    v_subrev_u32 v20, 229376, v126
    v_subrev_u32 v21, 229376, v127
    s_mov_b32 s53, 0
    s_mov_b32 s54, 0
    s_waitcnt lgkmcnt(0)
    s_mov_b32 s24, s4
    s_and_b32 s25, s5, 0xffff
    s_mov_b32 s26, 0x00400000
    s_mov_b32 s27, 0x20000
    s_mov_b32 s28, s12
    s_and_b32 s29, s13, 0xffff
    s_mov_b32 s30, 0x00700000
    s_mov_b32 s31, 0x20000
    s_sub_u32 s14, s14, 2048
    s_subb_u32 s15, s15, 0
    s_mov_b32 s32, s14
    s_and_b32 s33, s15, 0xffff
    s_mov_b32 s34, 0x00700800
    s_mov_b32 s35, 0x20000
    s_mov_b32 s36, s18
    s_and_b32 s37, s19, 0xffff
    s_mov_b32 s38, 0x02b00000
    s_mov_b32 s39, 0x20000
    s_mov_b32 s60, 0x01910000
    s_load_dword s44, s[18:19], s60
    s_mov_b32 s40, s22
    s_and_b32 s41, s23, 0xffff
    s_mov_b32 s42, 0x00000800
    s_mov_b32 s43, 0x20000
    buffer_load_dwordx4 v[64:67], v3, s[24:27], s63 offen
    buffer_load_dwordx4 v[68:71], v3, s[24:27], s63 offen offset:1024
    buffer_load_dwordx4 v[72:75], v3, s[24:27], s64 offen
    buffer_load_dwordx4 v[76:79], v3, s[24:27], s64 offen offset:1024
    buffer_load_dwordx4 v[80:83], v3, s[40:43], 0 offen
    buffer_load_dwordx4 v[84:87], v3, s[40:43], 0 offen offset:1024
    s_and_b32 s66, s48, 3
    s_lshl_b32 s66, s66, 13
    v_and_b32 v24, 15, v2
    v_lshlrev_b32 v25, 7, v24
    v_add_u32 v25, s66, v25
    v_lshrrev_b32 v26, 1, v24
    v_lshrrev_b32 v27, 4, v2
    v_xor_b32 v26, v26, v27
    v_lshlrev_b32 v26, 4, v26
    v_add_u32 v112, v25, v26
    v_xor_b32 v113, 64, v112
    v_lshrrev_b32 v24, 2, v2
    v_and_b32 v24, 3, v24
    v_lshlrev_b32 v25, 1, v24
    v_and_b32 v26, 1, v27
    v_add_u32 v25, v25, v26
    s_and_b32 s66, s48, 4
    v_xor_b32 v25, s66, v25
    v_lshlrev_b32 v25, 5, v25
    v_lshlrev_b32 v24, 8, v24
    v_add_u32 v24, v24, v25
    v_lshlrev_b32 v25, 12, v27
    v_add_u32 v24, v24, v25
    v_and_b32 v25, 3, v2
    v_lshlrev_b32 v25, 3, v25
    v_add_u32 v24, v24, v25
    v_add_u32 v118, 0x10000, v24
    v_xor_b32 v119, 32, v118
    v_xor_b32 v120, 64, v118
    v_xor_b32 v121, 96, v118
    v_mov_b32 v114, v118
    v_mov_b32 v115, v119
    v_mov_b32 v116, v120
    v_mov_b32 v117, v121
    s_lshl_b32 s77, s49, 4
    s_lshr_b32 s72, s50, 2
    s_lshl_b32 s72, s72, 1
    s_add_u32 s77, s77, s72
    s_and_b32 s72, s50, 1
    s_add_u32 s77, s77, s72
    s_add_u32 s72, s50, 1
    s_and_b32 s76, s72, 2
    s_mov_b32 s96, s24
    s_mov_b32 s97, s25
    s_mov_b32 s98, s26
    s_lshl_b32 s72, s77, 4
    s_sub_u32 s73, s48, 4
    s_lshl_b32 s73, s73, 2
    s_add_u32 s72, s72, s73
    v_add_u32 v0, s72, v2
    v_lshlrev_b32 v0, 11, v0
    s_mov_b32 s93, 128
    s_cmp_lg_u32 s76, 0
    s_cselect_b32 s94, 1, 15
    s_mov_b32 s95, 0
    s_mov_b32 s99, 0x20000
    s_mul_i32 s92, s93, 4
    s_sub_u32 m0, s56, 16384
    s_nop 0
    buffer_load_dwordx4 v16, s[24:27], s53 offen offset:0 lds
    buffer_load_dwordx4 v17, s[24:27], s53 offen offset:1024 lds
    buffer_load_dwordx4 v18, s[24:27], s53 offen offset:2048 lds
    buffer_load_dwordx4 v19, s[24:27], s53 offen offset:3072 lds
    s_add_u32 m0, m0, 16384
    s_nop 0
    buffer_load_dwordx4 v122, s[24:27], s53 offen offset:0 lds
    buffer_load_dwordx4 v123, s[24:27], s53 offen offset:1024 lds
    buffer_load_dwordx4 v124, s[24:27], s53 offen offset:2048 lds
    buffer_load_dwordx4 v125, s[24:27], s53 offen offset:3072 lds
    s_sub_u32 m0, s59, 16384
    s_nop 0
    buffer_load_dwordx4 v20, s[28:31], s54 offen offset:0 lds
    buffer_load_dwordx4 v21, s[28:31], s54 offen offset:1024 lds
    buffer_load_dwordx4 v20, s[32:35], s54 offen offset:2048 lds
    buffer_load_dwordx4 v21, s[32:35], s54 offen offset:3072 lds
    s_add_u32 m0, m0, 16384
    s_nop 0
    buffer_load_dwordx4 v126, s[28:31], s54 offen offset:0 lds
    buffer_load_dwordx4 v127, s[28:31], s54 offen offset:1024 lds
    buffer_load_dwordx4 v126, s[32:35], s54 offen offset:2048 lds
    buffer_load_dwordx4 v127, s[32:35], s54 offen offset:3072 lds
    s_mov_b32 s53, 128
    s_add_u32 s54, s54, 458752
    s_getpc_b64 s[74:75]
L_pc0:
    s_lshr_b32 s72, s2, 3
    s_and_b32 s72, s72, 7
    s_lshl_b32 s72, s72, 12
    s_sub_u32 s73, s48, 4
    s_lshl_b32 s73, s73, 10
    s_add_u32 s72, s72, s73
    v_lshlrev_b32 v24, 7, v2
    v_add_u32 v24, s72, v24
    v_min_u32 v24, L_p1_end-L_pc0, v24
    s_mov_b64 exec, 0xff
    global_load_dword v1, v24, s[74:75]
    s_mov_b64 exec, -1
    v_mov_b32 v63, v24
    s_mov_b64 s[16:17], s[74:75]
    s_waitcnt vmcnt(17)
    v_mov_b32 v14, 0
    v_mov_b32 v15, 0
    s_mov_b32 s72, 0x3f803f80
    v_and_b32 v8, 0xffff, v80
    v_and_b32 v9, 0xffff0000, v80
    v_dot2_f32_bf16 v24, v64, v8, 0
    v_dot2_f32_bf16 v25, v64, v9, 0
    v_dot2_f32_bf16 v26, v72, v8, 0
    v_dot2_f32_bf16 v27, v72, v9, 0
    s_nop 2
    v_cvt_pk_bf16_f32 v64, v24, v25
    v_cvt_pk_bf16_f32 v72, v26, v27
    v_and_b32 v8, 0xffff, v81
    v_and_b32 v9, 0xffff0000, v81
    v_dot2_f32_bf16 v28, v65, v8, 0
    v_dot2_f32_bf16 v29, v65, v9, 0
    v_dot2_f32_bf16 v30, v73, v8, 0
    v_dot2_f32_bf16 v31, v73, v9, 0
    v_dot2_f32_bf16 v14, v64, s72, v14
    v_dot2_f32_bf16 v15, v72, s72, v15
    s_nop 0
    v_cvt_pk_bf16_f32 v65, v28, v29
    v_cvt_pk_bf16_f32 v73, v30, v31
    v_and_b32 v8, 0xffff, v82
    v_and_b32 v9, 0xffff0000, v82
    v_dot2_f32_bf16 v24, v66, v8, 0
    v_dot2_f32_bf16 v25, v66, v9, 0
    v_dot2_f32_bf16 v26, v74, v8, 0
    v_dot2_f32_bf16 v27, v74, v9, 0
    v_dot2_f32_bf16 v14, v65, s72, v14
    v_dot2_f32_bf16 v15, v73, s72, v15
    s_nop 0
    v_cvt_pk_bf16_f32 v66, v24, v25
    v_cvt_pk_bf16_f32 v74, v26, v27
    v_and_b32 v8, 0xffff, v83
    v_and_b32 v9, 0xffff0000, v83
    v_dot2_f32_bf16 v28, v67, v8, 0
    v_dot2_f32_bf16 v29, v67, v9, 0
    v_dot2_f32_bf16 v30, v75, v8, 0
    v_dot2_f32_bf16 v31, v75, v9, 0
    v_dot2_f32_bf16 v14, v66, s72, v14
    v_dot2_f32_bf16 v15, v74, s72, v15
    s_nop 0
    v_cvt_pk_bf16_f32 v67, v28, v29
    v_cvt_pk_bf16_f32 v75, v30, v31
    v_and_b32 v8, 0xffff, v84
    v_and_b32 v9, 0xffff0000, v84
    v_dot2_f32_bf16 v24, v68, v8, 0
    v_dot2_f32_bf16 v25, v68, v9, 0
    v_dot2_f32_bf16 v26, v76, v8, 0
    v_dot2_f32_bf16 v27, v76, v9, 0
    v_dot2_f32_bf16 v14, v67, s72, v14
    v_dot2_f32_bf16 v15, v75, s72, v15
    s_nop 0
    v_cvt_pk_bf16_f32 v68, v24, v25
    v_cvt_pk_bf16_f32 v76, v26, v27
    v_and_b32 v8, 0xffff, v85
    v_and_b32 v9, 0xffff0000, v85
    v_dot2_f32_bf16 v28, v69, v8, 0
    v_dot2_f32_bf16 v29, v69, v9, 0
    v_dot2_f32_bf16 v30, v77, v8, 0
    v_dot2_f32_bf16 v31, v77, v9, 0
    v_dot2_f32_bf16 v14, v68, s72, v14
    v_dot2_f32_bf16 v15, v76, s72, v15
    s_nop 0
    v_cvt_pk_bf16_f32 v69, v28, v29
    v_cvt_pk_bf16_f32 v77, v30, v31
    v_and_b32 v8, 0xffff, v86
    v_and_b32 v9, 0xffff0000, v86
    v_dot2_f32_bf16 v24, v70, v8, 0
    v_dot2_f32_bf16 v25, v70, v9, 0
    v_dot2_f32_bf16 v26, v78, v8, 0
    v_dot2_f32_bf16 v27, v78, v9, 0
    v_dot2_f32_bf16 v14, v69, s72, v14
    v_dot2_f32_bf16 v15, v77, s72, v15
    s_nop 0
    v_cvt_pk_bf16_f32 v70, v24, v25
    v_cvt_pk_bf16_f32 v78, v26, v27
    v_and_b32 v8, 0xffff, v87
    v_and_b32 v9, 0xffff0000, v87
    v_dot2_f32_bf16 v28, v71, v8, 0
    v_dot2_f32_bf16 v29, v71, v9, 0
    v_dot2_f32_bf16 v30, v79, v8, 0
    v_dot2_f32_bf16 v31, v79, v9, 0
    v_dot2_f32_bf16 v14, v70, s72, v14
    v_dot2_f32_bf16 v15, v78, s72, v15
    s_nop 0
    v_cvt_pk_bf16_f32 v71, v28, v29
    v_cvt_pk_bf16_f32 v79, v30, v31
    v_dot2_f32_bf16 v14, v71, s72, v14
    v_dot2_f32_bf16 v15, v79, s72, v15
    s_add_u32 m0, s56, 16384
    s_nop 0
    buffer_load_dwordx4 v16, s[24:27], s53 offen offset:0 lds
    buffer_load_dwordx4 v17, s[24:27], s53 offen offset:1024 lds
    buffer_load_dwordx4 v18, s[24:27], s53 offen offset:2048 lds
    buffer_load_dwordx4 v19, s[24:27], s53 offen offset:3072 lds
    s_add_u32 m0, m0, 16384
    s_nop 0
    buffer_load_dwordx4 v122, s[24:27], s53 offen offset:0 lds
    buffer_load_dwordx4 v123, s[24:27], s53 offen offset:1024 lds
    buffer_load_dwordx4 v124, s[24:27], s53 offen offset:2048 lds
    buffer_load_dwordx4 v125, s[24:27], s53 offen offset:3072 lds
    s_add_u32 m0, s59, 16384
    s_nop 0
    buffer_load_dwordx4 v20, s[28:31], s54 offen offset:0 lds
    buffer_load_dwordx4 v21, s[28:31], s54 offen offset:1024 lds
    buffer_load_dwordx4 v20, s[32:35], s54 offen offset:2048 lds
    buffer_load_dwordx4 v21, s[32:35], s54 offen offset:3072 lds
    s_add_u32 m0, m0, 16384
    s_nop 0
    buffer_load_dwordx4 v126, s[28:31], s54 offen offset:0 lds
    buffer_load_dwordx4 v127, s[28:31], s54 offen offset:1024 lds
    buffer_load_dwordx4 v126, s[32:35], s54 offen offset:2048 lds
    buffer_load_dwordx4 v127, s[32:35], s54 offen offset:3072 lds
    s_mov_b32 s53, 128
    s_add_u32 s54, s54, 458752
    s_waitcnt vmcnt(17)
    s_branch L_p1_join
L_p1_fft:
    s_mov_b32 m0, s68
    s_mov_b32 s53, 128
    s_mov_b32 s54, 917504
    s_waitcnt lgkmcnt(0)
    s_mov_b32 s24, s4
    s_and_b32 s25, s5, 0xffff
    s_mov_b32 s26, 0x00400000
    s_mov_b32 s27, 0x20000
    buffer_load_dwordx4 v3, s[24:27], s63 offen lds
    buffer_load_dwordx4 v3, s[24:27], s63 offen offset:1024 lds
    s_add_u32 m0, m0, 8192
    s_nop 0
    buffer_load_dwordx4 v3, s[24:27], s64 offen lds
    buffer_load_dwordx4 v3, s[24:27], s64 offen offset:1024 lds
    s_mov_b32 s24, s4
    s_and_b32 s25, s5, 0xffff
    s_mov_b32 s26, 0x00400000
    s_mov_b32 s27, 0x20000
    s_mov_b32 s28, s12
    s_and_b32 s29, s13, 0xffff
    s_mov_b32 s30, 0x00700000
    s_mov_b32 s31, 0x20000
    s_sub_u32 s14, s14, 2048
    s_subb_u32 s15, s15, 0
    s_mov_b32 s32, s14
    s_and_b32 s33, s15, 0xffff
    s_mov_b32 s34, 0x00700800
    s_mov_b32 s35, 0x20000
    s_mov_b32 s36, s18
    s_and_b32 s37, s19, 0xffff
    s_mov_b32 s38, 0x02b00000
    s_mov_b32 s39, 0x20000
    s_mov_b32 s60, 0x01910000
    s_load_dword s44, s[18:19], s60
    s_lshl_b32 s66, s49, 8
    s_lshl_b32 s67, s48, 5
    s_add_u32 s66, s66, s67
    s_lshl_b32 s66, s66, 11
    v_lshrrev_b32 v4, 3, v2
    v_lshlrev_b32 v4, 11, v4
    v_add_u32 v4, s66, v4
    v_and_b32 v5, 7, v2
    v_lshrrev_b32 v6, 4, v2
    v_xor_b32 v5, v5, v6
    v_lshlrev_b32 v5, 4, v5
    v_add_u32 v122, v4, v5
    v_xor_b32 v5, 64, v5
    v_add_u32 v4, v4, v5
    v_add_u32 v123, 15360, v4
    v_add_u32 v124, 30720, v122
    v_add_u32 v125, 30720, v123
    s_lshl_b32 s66, s48, 3
    v_add_u32 v5, s66, v6
    v_mul_u32_u24 v5, 7168, v5
    s_and_b32 s66, s48, 1
    s_lshl_b32 s66, s66, 1
    s_mul_i32 s65, s50, 224
    v_lshlrev_b32 v4, 2, v6
    v_and_b32 v6, 15, v2
    v_xor_b32 v4, v4, v6
    v_xor_b32 v4, s66, v4
    v_cmp_gt_u32 vcc, 14, v4
    v_lshlrev_b32 v4, 4, v4
    v_add_u32 v5, v5, v4
    v_add_u32 v5, s65, v5
    v_mov_b32 v4, 0x7f000000
    v_cndmask_b32 v126, v4, v5, vcc
    v_add_u32 v127, 27648, v126
    s_and_b32 s66, s48, 3
    s_lshl_b32 s66, s66, 13
    v_and_b32 v8, 15, v2
    v_lshlrev_b32 v9, 7, v8
    v_add_u32 v9, s66, v9
    v_lshrrev_b32 v10, 1, v8
    v_lshrrev_b32 v11, 4, v2
    v_xor_b32 v10, v10, v11
    v_lshlrev_b32 v10, 4, v10
    v_add_u32 v112, v9, v10
    v_xor_b32 v113, 64, v112
    v_lshrrev_b32 v8, 2, v2
    v_and_b32 v8, 3, v8
    v_lshlrev_b32 v9, 1, v8
    v_and_b32 v10, 1, v11
    v_add_u32 v9, v9, v10
    s_and_b32 s66, s48, 4
    v_xor_b32 v9, s66, v9
    v_lshlrev_b32 v9, 5, v9
    v_lshlrev_b32 v8, 8, v8
    v_add_u32 v8, v8, v9
    v_lshlrev_b32 v9, 12, v11
    v_add_u32 v8, v8, v9
    v_and_b32 v9, 3, v2
    v_lshlrev_b32 v9, 3, v9
    v_add_u32 v8, v8, v9
    v_add_u32 v118, 0x10000, v8
    v_xor_b32 v119, 32, v118
    v_xor_b32 v120, 64, v118
    v_xor_b32 v121, 96, v118
    v_mov_b32 v114, v118
    v_mov_b32 v115, v119
    v_mov_b32 v116, v120
    v_mov_b32 v117, v121
    s_lshl_b32 s77, s49, 4
    s_lshr_b32 s72, s50, 2
    s_lshl_b32 s72, s72, 1
    s_add_u32 s77, s77, s72
    s_and_b32 s72, s50, 1
    s_add_u32 s77, s77, s72
    s_add_u32 s72, s50, 1
    s_and_b32 s76, s72, 2
    s_cmp_ge_u32 s48, 2
    s_cselect_b32 s96, s32, s28
    s_cselect_b32 s97, s33, s29
    s_cselect_b32 s98, s34, s30
    s_cselect_b32 s71, 2048, 0
    s_mul_i32 s72, s77, 3584
    s_and_b32 s73, s48, 1
    s_mul_i32 s73, s73, 1792
    s_add_u32 s72, s72, s73
    s_add_u32 s72, s72, s71
    v_lshlrev_b32 v0, 7, v2
    v_add_u32 v0, s72, v0
    s_mov_b32 s93, 458752
    s_cmp_lg_u32 s76, 0
    s_cselect_b32 s94, 1, 0x3fff
    s_mov_b32 s95, 0
    s_mov_b32 s99, 0x20000
    s_mul_i32 s92, s93, 4
    v_and_b32 v4, 31, v2
    v_lshrrev_b32 v5, 5, v2
    v_cvt_f32_u32 v8, v4
    v_cvt_f32_u32 v9, v5
    v_and_b32 v10, 1, v2
    v_mul_u32_u24 v10, 0x8000, v10
    v_mul_u32_u24 v10, 0x10001, v10
    v_mul_f32 v9, v8, v9
    v_mul_f32 v11, 0x3e000000, v9
    v_fmamk_f32 v12, v8, 0x00000000, v11
    v_fract_f32 v12, v12
    v_cos_f32 v40, v12
    v_sin_f32 v48, v12
    v_fmamk_f32 v13, v8, 0x3d000000, v11
    v_fract_f32 v13, v13
    v_cos_f32 v41, v13
    v_sin_f32 v49, v13
    v_fmamk_f32 v14, v8, 0x3d800000, v11
    v_fract_f32 v14, v14
    v_cos_f32 v42, v14
    v_sin_f32 v50, v14
    v_fmamk_f32 v15, v8, 0x3dc00000, v11
    v_fract_f32 v15, v15
    v_cos_f32 v43, v15
    v_sin_f32 v51, v15
    v_fmamk_f32 v12, v8, 0x3e800000, v11
    v_fract_f32 v12, v12
    v_cos_f32 v44, v12
    v_sin_f32 v52, v12
    v_fmamk_f32 v13, v8, 0x3e900000, v11
    v_fract_f32 v13, v13
    v_cos_f32 v45, v13
    v_sin_f32 v53, v13
    v_fmamk_f32 v14, v8, 0x3ea00000, v11
    v_fract_f32 v14, v14
    v_cos_f32 v46, v14
    v_sin_f32 v54, v14
    v_fmamk_f32 v15, v8, 0x3eb00000, v11
    v_fract_f32 v15, v15
    v_cos_f32 v47, v15
    v_sin_f32 v55, v15
    v_mul_f32 v11, 0x3b800000, v9
    v_cvt_pk_bf16_f32 v16, v40, v41
    v_cvt_pk_bf16_f32 v24, v48, v49
    v_cvt_pk_bf16_f32 v17, v42, v43
    v_cvt_pk_bf16_f32 v25, v50, v51
    v_cvt_pk_bf16_f32 v18, v44, v45
    v_cvt_pk_bf16_f32 v26, v52, v53
    v_cvt_pk_bf16_f32 v19, v46, v47
    v_cvt_pk_bf16_f32 v27, v54, v55
    v_xor_b32 v20, v16, v10
    v_xor_b32 v28, v24, v10
    v_xor_b32 v21, v17, v10
    v_xor_b32 v29, v25, v10
    v_xor_b32 v22, v18, v10
    v_xor_b32 v30, v26, v10
    v_xor_b32 v23, v19, v10
    v_xor_b32 v31, v27, v10
    v_xor_b32 v32, 0x80008000, v24
    v_xor_b32 v33, 0x80008000, v25
    v_xor_b32 v34, 0x80008000, v26
    v_xor_b32 v35, 0x80008000, v27
    v_xor_b32 v36, 0x80008000, v28
    v_xor_b32 v37, 0x80008000, v29
    v_xor_b32 v38, 0x80008000, v30
    v_xor_b32 v39, 0x80008000, v31
    v_lshlrev_b32 v6, 8, v5
    v_lshrrev_b32 v7, 2, v2
    v_and_b32 v7, 3, v7
    v_lshlrev_b32 v7, 6, v7
    v_add_u32 v6, v6, v7
    v_and_b32 v7, 16, v2
    v_lshlrev_b32 v7, 1, v7
    v_add_u32 v6, v6, v7
    v_and_b32 v7, 3, v2
    v_lshlrev_b32 v7, 3, v7
    v_add_u32 v6, v6, v7
    v_add_u32 v6, s68, v6
    v_fmamk_f32 v12, v8, 0x00000000, v11
    v_cos_f32 v128, v12
    v_sin_f32 v144, v12
    v_fmamk_f32 v13, v8, 0x3a800000, v11
    v_cos_f32 v129, v13
    v_sin_f32 v145, v13
    v_fmamk_f32 v14, v8, 0x3b000000, v11
    v_cos_f32 v130, v14
    v_sin_f32 v146, v14
    v_fmamk_f32 v15, v8, 0x3b400000, v11
    v_cos_f32 v131, v15
    v_sin_f32 v147, v15
    v_fmamk_f32 v12, v8, 0x3c000000, v11
    v_cos_f32 v132, v12
    v_sin_f32 v148, v12
    v_fmamk_f32 v13, v8, 0x3c100000, v11
    v_cos_f32 v133, v13
    v_sin_f32 v149, v13
    v_fmamk_f32 v14, v8, 0x3c200000, v11
    v_cos_f32 v134, v14
    v_sin_f32 v150, v14
    v_fmamk_f32 v15, v8, 0x3c300000, v11
    v_cos_f32 v135, v15
    v_sin_f32 v151, v15
    v_fmamk_f32 v12, v8, 0x3c800000, v11
    v_cos_f32 v136, v12
    v_sin_f32 v152, v12
    v_fmamk_f32 v13, v8, 0x3c880000, v11
    v_cos_f32 v137, v13
    v_sin_f32 v153, v13
    v_fmamk_f32 v14, v8, 0x3c900000, v11
    v_cos_f32 v138, v14
    v_sin_f32 v154, v14
    v_fmamk_f32 v15, v8, 0x3c980000, v11
    v_cos_f32 v139, v15
    v_sin_f32 v155, v15
    v_fmamk_f32 v12, v8, 0x3cc00000, v11
    v_cos_f32 v140, v12
    v_sin_f32 v156, v12
    v_fmamk_f32 v13, v8, 0x3cc80000, v11
    v_cos_f32 v141, v13
    v_sin_f32 v157, v13
    v_fmamk_f32 v14, v8, 0x3cd00000, v11
    v_cos_f32 v142, v14
    v_sin_f32 v158, v14
    v_fmamk_f32 v15, v8, 0x3cd80000, v11
    v_cos_f32 v143, v15
    v_sin_f32 v159, v15
    v_lshlrev_b32 v12, 4, v4
    v_lshlrev_b32 v13, 11, v5
    v_add_u32 v12, v12, v13
    s_lshl_b32 s62, s48, 2
    s_add_u32 s62, s62, 147456
    v_add_u32 v12, s62, v12
    s_waitcnt lgkmcnt(0)
    s_waitcnt vmcnt(0)
    ds_read_b64_tr_b16 v[56:57], v6 offset:0
    ds_read_b64_tr_b16 v[58:59], v6 offset:512
    ds_read_b64_tr_b16 v[60:61], v6 offset:1024
    ds_read_b64_tr_b16 v[62:63], v6 offset:1536
    ds_read_b64_tr_b16 v[104:105], v6 offset:8192
    ds_read_b64_tr_b16 v[106:107], v6 offset:8704
    ds_read_b64_tr_b16 v[108:109], v6 offset:9216
    ds_read_b64_tr_b16 v[110:111], v6 offset:9728
    s_waitcnt lgkmcnt(4)
    v_mfma_f32_32x32x16_bf16 v[160:175], v[56:59], v[16:19], 0
    v_mfma_f32_32x32x16_bf16 v[176:191], v[56:59], v[32:35], 0
    v_mfma_f32_32x32x16_bf16 v[160:175], v[60:63], v[20:23], v[160:175]
    v_mfma_f32_32x32x16_bf16 v[176:191], v[60:63], v[36:39], v[176:191]
    s_waitcnt lgkmcnt(0)
    v_mfma_f32_32x32x16_bf16 v[192:207], v[104:107], v[16:19], 0
    v_mfma_f32_32x32x16_bf16 v[208:223], v[104:107], v[32:35], 0
    v_mfma_f32_32x32x16_bf16 v[192:207], v[108:111], v[20:23], v[192:207]
    v_mfma_f32_32x32x16_bf16 v[208:223], v[108:111], v[36:39], v[208:223]
    s_nop 7
    v_pk_mul_f32 v[56:57], v[160:161], v[128:129]
    v_pk_mul_f32 v[58:59], v[176:177], v[128:129]
    v_pk_fma_f32 v[56:57], v[176:177], v[144:145], v[56:57]
    v_pk_fma_f32 v[58:59], v[160:161], v[144:145], v[58:59] neg_lo:[1,0,0] neg_hi:[1,0,0]
    v_cvt_pk_bf16_f32 v40, v56, v57
    v_cvt_pk_bf16_f32 v48, v58, v59
    v_pk_mul_f32 v[60:61], v[162:163], v[130:131]
    v_pk_mul_f32 v[62:63], v[178:179], v[130:131]
    v_pk_fma_f32 v[60:61], v[178:179], v[146:147], v[60:61]
    v_pk_fma_f32 v[62:63], v[162:163], v[146:147], v[62:63] neg_lo:[1,0,0] neg_hi:[1,0,0]
    v_cvt_pk_bf16_f32 v41, v60, v61
    v_cvt_pk_bf16_f32 v49, v62, v63
    v_pk_mul_f32 v[56:57], v[164:165], v[132:133]
    v_pk_mul_f32 v[58:59], v[180:181], v[132:133]
    v_pk_fma_f32 v[56:57], v[180:181], v[148:149], v[56:57]
    v_pk_fma_f32 v[58:59], v[164:165], v[148:149], v[58:59] neg_lo:[1,0,0] neg_hi:[1,0,0]
    v_cvt_pk_bf16_f32 v42, v56, v57
    v_cvt_pk_bf16_f32 v50, v58, v59
    v_pk_mul_f32 v[60:61], v[166:167], v[134:135]
    v_pk_mul_f32 v[62:63], v[182:183], v[134:135]
    v_pk_fma_f32 v[60:61], v[182:183], v[150:151], v[60:61]
    v_pk_fma_f32 v[62:63], v[166:167], v[150:151], v[62:63] neg_lo:[1,0,0] neg_hi:[1,0,0]
    v_cvt_pk_bf16_f32 v43, v60, v61
    v_cvt_pk_bf16_f32 v51, v62, v63
    v_pk_mul_f32 v[56:57], v[168:169], v[136:137]
    v_pk_mul_f32 v[58:59], v[184:185], v[136:137]
    v_pk_fma_f32 v[56:57], v[184:185], v[152:153], v[56:57]
    v_pk_fma_f32 v[58:59], v[168:169], v[152:153], v[58:59] neg_lo:[1,0,0] neg_hi:[1,0,0]
    v_cvt_pk_bf16_f32 v44, v56, v57
    v_cvt_pk_bf16_f32 v52, v58, v59
    v_pk_mul_f32 v[60:61], v[170:171], v[138:139]
    v_pk_mul_f32 v[62:63], v[186:187], v[138:139]
    v_pk_fma_f32 v[60:61], v[186:187], v[154:155], v[60:61]
    v_pk_fma_f32 v[62:63], v[170:171], v[154:155], v[62:63] neg_lo:[1,0,0] neg_hi:[1,0,0]
    v_cvt_pk_bf16_f32 v45, v60, v61
    v_cvt_pk_bf16_f32 v53, v62, v63
    v_pk_mul_f32 v[56:57], v[172:173], v[140:141]
    v_pk_mul_f32 v[58:59], v[188:189], v[140:141]
    v_pk_fma_f32 v[56:57], v[188:189], v[156:157], v[56:57]
    v_pk_fma_f32 v[58:59], v[172:173], v[156:157], v[58:59] neg_lo:[1,0,0] neg_hi:[1,0,0]
    v_cvt_pk_bf16_f32 v46, v56, v57
    v_cvt_pk_bf16_f32 v54, v58, v59
    v_pk_mul_f32 v[60:61], v[174:175], v[142:143]
    v_pk_mul_f32 v[62:63], v[190:191], v[142:143]
    v_pk_fma_f32 v[60:61], v[190:191], v[158:159], v[60:61]
    v_pk_fma_f32 v[62:63], v[174:175], v[158:159], v[62:63] neg_lo:[1,0,0] neg_hi:[1,0,0]
    v_cvt_pk_bf16_f32 v47, v60, v61
    v_cvt_pk_bf16_f32 v55, v62, v63
    s_nop 1
    v_mfma_f32_32x32x16_bf16 v[224:239], v[16:19], v[40:43], 0
    v_mfma_f32_32x32x16_bf16 v[240:255], v[16:19], v[48:51], 0
    v_mfma_f32_32x32x16_bf16 v[224:239], v[24:27], v[48:51], v[224:239]
    v_mfma_f32_32x32x16_bf16 v[240:255], v[32:35], v[40:43], v[240:255]
    v_mfma_f32_32x32x16_bf16 v[224:239], v[20:23], v[44:47], v[224:239]
    v_mfma_f32_32x32x16_bf16 v[240:255], v[20:23], v[52:55], v[240:255]
    v_mfma_f32_32x32x16_bf16 v[224:239], v[28:31], v[52:55], v[224:239]
    v_mfma_f32_32x32x16_bf16 v[240:255], v[36:39], v[44:47], v[240:255]
    v_pk_mul_f32 v[56:57], v[192:193], v[128:129]
    v_pk_mul_f32 v[58:59], v[208:209], v[128:129]
    v_pk_fma_f32 v[56:57], v[208:209], v[144:145], v[56:57]
    v_pk_fma_f32 v[58:59], v[192:193], v[144:145], v[58:59] neg_lo:[1,0,0] neg_hi:[1,0,0]
    v_cvt_pk_bf16_f32 v88, v56, v57
    v_cvt_pk_bf16_f32 v96, v58, v59
    v_pk_mul_f32 v[60:61], v[194:195], v[130:131]
    v_pk_mul_f32 v[62:63], v[210:211], v[130:131]
    v_pk_fma_f32 v[60:61], v[210:211], v[146:147], v[60:61]
    v_pk_fma_f32 v[62:63], v[194:195], v[146:147], v[62:63] neg_lo:[1,0,0] neg_hi:[1,0,0]
    v_cvt_pk_bf16_f32 v89, v60, v61
    v_cvt_pk_bf16_f32 v97, v62, v63
    v_pk_mul_f32 v[56:57], v[196:197], v[132:133]
    v_pk_mul_f32 v[58:59], v[212:213], v[132:133]
    v_pk_fma_f32 v[56:57], v[212:213], v[148:149], v[56:57]
    v_pk_fma_f32 v[58:59], v[196:197], v[148:149], v[58:59] neg_lo:[1,0,0] neg_hi:[1,0,0]
    v_cvt_pk_bf16_f32 v90, v56, v57
    v_cvt_pk_bf16_f32 v98, v58, v59
    v_pk_mul_f32 v[60:61], v[198:199], v[134:135]
    v_pk_mul_f32 v[62:63], v[214:215], v[134:135]
    v_pk_fma_f32 v[60:61], v[214:215], v[150:151], v[60:61]
    v_pk_fma_f32 v[62:63], v[198:199], v[150:151], v[62:63] neg_lo:[1,0,0] neg_hi:[1,0,0]
    v_cvt_pk_bf16_f32 v91, v60, v61
    v_cvt_pk_bf16_f32 v99, v62, v63
    v_pk_mul_f32 v[56:57], v[200:201], v[136:137]
    v_pk_mul_f32 v[58:59], v[216:217], v[136:137]
    v_pk_fma_f32 v[56:57], v[216:217], v[152:153], v[56:57]
    v_pk_fma_f32 v[58:59], v[200:201], v[152:153], v[58:59] neg_lo:[1,0,0] neg_hi:[1,0,0]
    v_cvt_pk_bf16_f32 v92, v56, v57
    v_cvt_pk_bf16_f32 v100, v58, v59
    v_pk_mul_f32 v[60:61], v[202:203], v[138:139]
    v_pk_mul_f32 v[62:63], v[218:219], v[138:139]
    v_pk_fma_f32 v[60:61], v[218:219], v[154:155], v[60:61]
    v_pk_fma_f32 v[62:63], v[202:203], v[154:155], v[62:63] neg_lo:[1,0,0] neg_hi:[1,0,0]
    v_cvt_pk_bf16_f32 v93, v60, v61
    v_cvt_pk_bf16_f32 v101, v62, v63
    v_pk_mul_f32 v[56:57], v[204:205], v[140:141]
    v_pk_mul_f32 v[58:59], v[220:221], v[140:141]
    v_pk_fma_f32 v[56:57], v[220:221], v[156:157], v[56:57]
    v_pk_fma_f32 v[58:59], v[204:205], v[156:157], v[58:59] neg_lo:[1,0,0] neg_hi:[1,0,0]
    v_cvt_pk_bf16_f32 v94, v56, v57
    v_cvt_pk_bf16_f32 v102, v58, v59
    v_pk_mul_f32 v[60:61], v[206:207], v[142:143]
    v_pk_mul_f32 v[62:63], v[222:223], v[142:143]
    v_pk_fma_f32 v[60:61], v[222:223], v[158:159], v[60:61]
    v_pk_fma_f32 v[62:63], v[206:207], v[158:159], v[62:63] neg_lo:[1,0,0] neg_hi:[1,0,0]
    v_cvt_pk_bf16_f32 v95, v60, v61
    v_cvt_pk_bf16_f32 v103, v62, v63
    s_nop 1
    v_mfma_f32_32x32x16_bf16 v[160:175], v[16:19], v[88:91], 0
    v_mfma_f32_32x32x16_bf16 v[176:191], v[16:19], v[96:99], 0
    v_mfma_f32_32x32x16_bf16 v[160:175], v[24:27], v[96:99], v[160:175]
    v_mfma_f32_32x32x16_bf16 v[176:191], v[32:35], v[88:91], v[176:191]
    v_mfma_f32_32x32x16_bf16 v[160:175], v[20:23], v[92:95], v[160:175]
    v_mfma_f32_32x32x16_bf16 v[176:191], v[20:23], v[100:103], v[176:191]
    v_mfma_f32_32x32x16_bf16 v[160:175], v[28:31], v[100:103], v[160:175]
    v_mfma_f32_32x32x16_bf16 v[176:191], v[36:39], v[92:95], v[176:191]
    s_nop 11
    v_cvt_pk_bf16_f32 v200, v224, v160
    ds_write_b32 v12, v200 offset:0
    v_cvt_pk_bf16_f32 v201, v225, v161
    ds_write_b32 v12, v201 offset:512
    v_cvt_pk_bf16_f32 v202, v226, v162
    ds_write_b32 v12, v202 offset:1024
    v_cvt_pk_bf16_f32 v203, v227, v163
    ds_write_b32 v12, v203 offset:1536
    v_cvt_pk_bf16_f32 v204, v228, v164
    ds_write_b32 v12, v204 offset:4096
    v_cvt_pk_bf16_f32 v205, v229, v165
    ds_write_b32 v12, v205 offset:4608
    v_cvt_pk_bf16_f32 v206, v230, v166
    ds_write_b32 v12, v206 offset:5120
    v_cvt_pk_bf16_f32 v207, v231, v167
    ds_write_b32 v12, v207 offset:5632
    v_cvt_pk_bf16_f32 v208, v240, v176
    ds_write_b32 v12, v208 offset:8192
    v_cvt_pk_bf16_f32 v209, v241, v177
    ds_write_b32 v12, v209 offset:8704
    v_cvt_pk_bf16_f32 v210, v242, v178
    ds_write_b32 v12, v210 offset:9216
    v_cvt_pk_bf16_f32 v211, v243, v179
    ds_write_b32 v12, v211 offset:9728
    v_cvt_pk_bf16_f32 v212, v244, v180
    ds_write_b32 v12, v212 offset:12288
    v_cvt_pk_bf16_f32 v213, v245, v181
    ds_write_b32 v12, v213 offset:12800
    v_cvt_pk_bf16_f32 v214, v246, v182
    ds_write_b32 v12, v214 offset:13312
    v_cvt_pk_bf16_f32 v215, v247, v183
    ds_write_b32 v12, v215 offset:13824
    v_cvt_pk_bf16_f32 v12, v232, v168
L_p1_join:
    s_lshl_b32 s62, s48, 10
    s_add_u32 s62, s62, 147456
    v_and_b32 v13, 1, v2
    v_lshlrev_b32 v13, 13, v13
    v_lshrrev_b32 v4, 1, v2
    v_lshlrev_b32 v4, 4, v4
    v_add3_u32 v13, v13, v4, s62
    s_waitcnt lgkmcnt(0)
    s_barrier
    s_add_u32 s44, s44, 1
    s_mov_b32 s101, 0
    ds_read_b128 v[4:7], v13
    ds_read_b128 v[8:11], v13 offset:512
    s_cmp_ge_u32 s48, 4
    s_cbranch_scc1 L_p1_g1
    ds_read_b128 v[16:19], v112 offset:0
    ds_read_b64_tr_b16 v[32:33], v114 offset:0
    ds_read_b64_tr_b16 v[34:35], v114 offset:1024
    ds_read_b64_tr_b16 v[36:37], v114 offset:2048
    ds_read_b64_tr_b16 v[38:39], v114 offset:3072
    ds_read_b64_tr_b16 v[40:41], v115 offset:0
    ds_read_b64_tr_b16 v[42:43], v115 offset:1024
    ds_read_b64_tr_b16 v[44:45], v115 offset:2048
    ds_read_b64_tr_b16 v[46:47], v115 offset:3072
    ds_read_b64_tr_b16 v[48:49], v116 offset:0
    ds_read_b64_tr_b16 v[50:51], v116 offset:1024
    ds_read_b64_tr_b16 v[52:53], v116 offset:2048
    ds_read_b64_tr_b16 v[54:55], v116 offset:3072
    ds_read_b64_tr_b16 v[56:57], v117 offset:0
    ds_read_b64_tr_b16 v[58:59], v117 offset:1024
    ds_read_b64_tr_b16 v[60:61], v117 offset:2048
    ds_read_b64_tr_b16 v[62:63], v117 offset:3072
    ds_read_b128 v[20:23], v112 offset:2048
    ds_read_b128 v[24:27], v112 offset:4096
    ds_read_b128 v[28:31], v112 offset:6144
    s_waitcnt lgkmcnt(0)
    s_barrier
    s_waitcnt lgkmcnt(0)
    v_mfma_f32_16x16x32_bf16 v[128:131], v[32:35], v[16:19], 0
    ds_read_b128 v[64:67], v113 offset:0
    v_mfma_f32_16x16x32_bf16 v[160:163], v[32:35], v[20:23], 0
    ds_read_b64_tr_b16 v[80:81], v114 offset:16384
    s_add_u32 m0, s57, s59
    v_mfma_f32_16x16x32_bf16 v[192:195], v[32:35], v[24:27], 0
    ds_read_b64_tr_b16 v[82:83], v114 offset:17408
    buffer_load_dwordx4 v126, s[28:31], s54 offen offset:0 lds
    v_mfma_f32_16x16x32_bf16 v[224:227], v[32:35], v[28:31], 0
    ds_read_b64_tr_b16 v[84:85], v114 offset:18432
    s_add_u32 s60, s57, 32768
    s_cmp_ge_u32 s60, 98304
    s_cselect_b32 s57, 0, s60
    v_mfma_f32_16x16x32_bf16 v[228:231], v[36:39], v[28:31], 0
    ds_read_b64_tr_b16 v[86:87], v114 offset:19456
    v_mfma_f32_16x16x32_bf16 v[196:199], v[36:39], v[24:27], 0
    ds_read_b64_tr_b16 v[88:89], v115 offset:16384
    s_add_u32 s60, s57, 32768
    s_cmp_ge_u32 s60, 98304
    s_cselect_b32 s61, 0, s60
    v_mfma_f32_16x16x32_bf16 v[164:167], v[36:39], v[20:23], 0
    ds_read_b64_tr_b16 v[90:91], v115 offset:17408
    v_mfma_f32_16x16x32_bf16 v[132:135], v[36:39], v[16:19], 0
    ds_read_b64_tr_b16 v[92:93], v115 offset:18432
    v_mfma_f32_16x16x32_bf16 v[136:139], v[40:43], v[16:19], 0
    ds_read_b64_tr_b16 v[94:95], v115 offset:19456
    buffer_load_dwordx4 v127, s[28:31], s54 offen offset:1024 lds
    v_mfma_f32_16x16x32_bf16 v[168:171], v[40:43], v[20:23], 0
    ds_read_b64_tr_b16 v[96:97], v116 offset:16384
    v_mfma_f32_16x16x32_bf16 v[200:203], v[40:43], v[24:27], 0
    ds_read_b64_tr_b16 v[98:99], v116 offset:17408
    v_mfma_f32_16x16x32_bf16 v[232:235], v[40:43], v[28:31], 0
    ds_read_b64_tr_b16 v[100:101], v116 offset:18432
    v_mfma_f32_16x16x32_bf16 v[236:239], v[44:47], v[28:31], 0
    ds_read_b64_tr_b16 v[102:103], v116 offset:19456
    v_mfma_f32_16x16x32_bf16 v[204:207], v[44:47], v[24:27], 0
    ds_read_b64_tr_b16 v[104:105], v117 offset:16384
    v_mfma_f32_16x16x32_bf16 v[172:175], v[44:47], v[20:23], 0
    ds_read_b64_tr_b16 v[106:107], v117 offset:17408
    buffer_load_dwordx4 v126, s[32:35], s54 offen offset:2048 lds
    v_mfma_f32_16x16x32_bf16 v[140:143], v[44:47], v[16:19], 0
    ds_read_b64_tr_b16 v[108:109], v117 offset:18432
    v_mfma_f32_16x16x32_bf16 v[144:147], v[48:51], v[16:19], 0
    ds_read_b64_tr_b16 v[110:111], v117 offset:19456
    v_mfma_f32_16x16x32_bf16 v[176:179], v[48:51], v[20:23], 0
    ds_read_b128 v[68:71], v113 offset:2048
    v_mfma_f32_16x16x32_bf16 v[208:211], v[48:51], v[24:27], 0
    ds_read_b128 v[72:75], v113 offset:4096
    v_mfma_f32_16x16x32_bf16 v[240:243], v[48:51], v[28:31], 0
    ds_read_b128 v[76:79], v113 offset:6144
    v_mfma_f32_16x16x32_bf16 v[244:247], v[52:55], v[28:31], 0
    buffer_load_dwordx4 v127, s[32:35], s54 offen offset:3072 lds
    v_xor_b32 v112, 0x8000, v112
    v_mfma_f32_16x16x32_bf16 v[212:215], v[52:55], v[24:27], 0
    s_add_u32 s54, s54, 458752
    s_add_u32 s53, s53, 128
    v_xor_b32 v113, 0x8000, v113
    v_mfma_f32_16x16x32_bf16 v[180:183], v[52:55], v[20:23], 0
    v_add_u32 v114, s61, v118
    v_mfma_f32_16x16x32_bf16 v[148:151], v[52:55], v[16:19], 0
    v_add_u32 v115, s61, v119
    v_mfma_f32_16x16x32_bf16 v[152:155], v[56:59], v[16:19], 0
    v_add_u32 v116, s61, v120
    v_mfma_f32_16x16x32_bf16 v[184:187], v[56:59], v[20:23], 0
    v_add_u32 v117, s61, v121
    v_mfma_f32_16x16x32_bf16 v[216:219], v[56:59], v[24:27], 0
    v_mfma_f32_16x16x32_bf16 v[248:251], v[56:59], v[28:31], 0
    v_mfma_f32_16x16x32_bf16 v[252:255], v[60:63], v[28:31], 0
    v_mfma_f32_16x16x32_bf16 v[220:223], v[60:63], v[24:27], 0
    v_mfma_f32_16x16x32_bf16 v[188:191], v[60:63], v[20:23], 0
    s_mov_b64 exec, s[94:95]
    buffer_load_dword v1, v0, s[96:99], s92 offen
    s_mov_b64 exec, -1
    s_add_u32 s92, s92, s93
    v_mfma_f32_16x16x32_bf16 v[156:159], v[60:63], v[16:19], 0
    .p2align 6
L_loop_n4:
    s_mov_b32 m0, s56
    s_waitcnt vmcnt(5) lgkmcnt(0)
    s_barrier
    v_mfma_f32_16x16x32_bf16 v[128:131], v[80:83], v[64:67], v[128:131]
    ds_read_b128 v[16:19], v112 offset:0
    buffer_load_dwordx4 v122, s[24:27], s53 offen offset:0 lds
    v_mfma_f32_16x16x32_bf16 v[160:163], v[80:83], v[68:71], v[160:163]
    ds_read_b64_tr_b16 v[32:33], v114 offset:0
    v_mfma_f32_16x16x32_bf16 v[192:195], v[80:83], v[72:75], v[192:195]
    ds_read_b64_tr_b16 v[34:35], v114 offset:1024
    v_mfma_f32_16x16x32_bf16 v[224:227], v[80:83], v[76:79], v[224:227]
    ds_read_b64_tr_b16 v[36:37], v114 offset:2048
    v_mfma_f32_16x16x32_bf16 v[228:231], v[84:87], v[76:79], v[228:231]
    ds_read_b64_tr_b16 v[38:39], v114 offset:3072
    buffer_load_dwordx4 v123, s[24:27], s53 offen offset:1024 lds
    v_mfma_f32_16x16x32_bf16 v[196:199], v[84:87], v[72:75], v[196:199]
    ds_read_b64_tr_b16 v[40:41], v115 offset:0
    v_mfma_f32_16x16x32_bf16 v[164:167], v[84:87], v[68:71], v[164:167]
    ds_read_b64_tr_b16 v[42:43], v115 offset:1024
    v_mfma_f32_16x16x32_bf16 v[132:135], v[84:87], v[64:67], v[132:135]
    ds_read_b64_tr_b16 v[44:45], v115 offset:2048
    v_mfma_f32_16x16x32_bf16 v[136:139], v[88:91], v[64:67], v[136:139]
    ds_read_b64_tr_b16 v[46:47], v115 offset:3072
    buffer_load_dwordx4 v124, s[24:27], s53 offen offset:2048 lds
    v_mfma_f32_16x16x32_bf16 v[168:171], v[88:91], v[68:71], v[168:171]
    ds_read_b64_tr_b16 v[48:49], v116 offset:0
    v_mfma_f32_16x16x32_bf16 v[200:203], v[88:91], v[72:75], v[200:203]
    ds_read_b64_tr_b16 v[50:51], v116 offset:1024
    v_mfma_f32_16x16x32_bf16 v[232:235], v[88:91], v[76:79], v[232:235]
    ds_read_b64_tr_b16 v[52:53], v116 offset:2048
    v_mfma_f32_16x16x32_bf16 v[236:239], v[92:95], v[76:79], v[236:239]
    ds_read_b64_tr_b16 v[54:55], v116 offset:3072
    buffer_load_dwordx4 v125, s[24:27], s53 offen offset:3072 lds
    v_mfma_f32_16x16x32_bf16 v[204:207], v[92:95], v[72:75], v[204:207]
    ds_read_b64_tr_b16 v[56:57], v117 offset:0
    v_mfma_f32_16x16x32_bf16 v[172:175], v[92:95], v[68:71], v[172:175]
    ds_read_b64_tr_b16 v[58:59], v117 offset:1024
    v_mfma_f32_16x16x32_bf16 v[140:143], v[92:95], v[64:67], v[140:143]
    ds_read_b64_tr_b16 v[60:61], v117 offset:2048
    v_mfma_f32_16x16x32_bf16 v[144:147], v[96:99], v[64:67], v[144:147]
    ds_read_b64_tr_b16 v[62:63], v117 offset:3072
    v_mfma_f32_16x16x32_bf16 v[176:179], v[96:99], v[68:71], v[176:179]
    ds_read_b128 v[20:23], v112 offset:2048
    v_mfma_f32_16x16x32_bf16 v[208:211], v[96:99], v[72:75], v[208:211]
    ds_read_b128 v[24:27], v112 offset:4096
    v_mfma_f32_16x16x32_bf16 v[240:243], v[96:99], v[76:79], v[240:243]
    ds_read_b128 v[28:31], v112 offset:6144
    v_mfma_f32_16x16x32_bf16 v[244:247], v[100:103], v[76:79], v[244:247]
    s_xor_b32 s56, s56, 0x8000
    v_mfma_f32_16x16x32_bf16 v[212:215], v[100:103], v[72:75], v[212:215]
    v_mfma_f32_16x16x32_bf16 v[180:183], v[100:103], v[68:71], v[180:183]
    v_mfma_f32_16x16x32_bf16 v[148:151], v[100:103], v[64:67], v[148:151]
    v_mfma_f32_16x16x32_bf16 v[152:155], v[104:107], v[64:67], v[152:155]
    v_mfma_f32_16x16x32_bf16 v[184:187], v[104:107], v[68:71], v[184:187]
    v_mfma_f32_16x16x32_bf16 v[216:219], v[104:107], v[72:75], v[216:219]
    v_mfma_f32_16x16x32_bf16 v[248:251], v[104:107], v[76:79], v[248:251]
    v_mfma_f32_16x16x32_bf16 v[252:255], v[108:111], v[76:79], v[252:255]
    v_mfma_f32_16x16x32_bf16 v[220:223], v[108:111], v[72:75], v[220:223]
    v_mfma_f32_16x16x32_bf16 v[188:191], v[108:111], v[68:71], v[188:191]
    v_mfma_f32_16x16x32_bf16 v[156:159], v[108:111], v[64:67], v[156:159]
    s_waitcnt lgkmcnt(0)
    v_mfma_f32_16x16x32_bf16 v[128:131], v[32:35], v[16:19], v[128:131]
    ds_read_b128 v[64:67], v113 offset:0
    v_mfma_f32_16x16x32_bf16 v[160:163], v[32:35], v[20:23], v[160:163]
    ds_read_b64_tr_b16 v[80:81], v114 offset:16384
    s_add_u32 m0, s57, s59
    v_mfma_f32_16x16x32_bf16 v[192:195], v[32:35], v[24:27], v[192:195]
    ds_read_b64_tr_b16 v[82:83], v114 offset:17408
    buffer_load_dwordx4 v126, s[28:31], s54 offen offset:0 lds
    v_mfma_f32_16x16x32_bf16 v[224:227], v[32:35], v[28:31], v[224:227]
    ds_read_b64_tr_b16 v[84:85], v114 offset:18432
    s_add_u32 s60, s57, 32768
    s_cmp_ge_u32 s60, 98304
    s_cselect_b32 s57, 0, s60
    v_mfma_f32_16x16x32_bf16 v[228:231], v[36:39], v[28:31], v[228:231]
    ds_read_b64_tr_b16 v[86:87], v114 offset:19456
    v_mfma_f32_16x16x32_bf16 v[196:199], v[36:39], v[24:27], v[196:199]
    ds_read_b64_tr_b16 v[88:89], v115 offset:16384
    s_add_u32 s60, s57, 32768
    s_cmp_ge_u32 s60, 98304
    s_cselect_b32 s61, 0, s60
    v_mfma_f32_16x16x32_bf16 v[164:167], v[36:39], v[20:23], v[164:167]
    ds_read_b64_tr_b16 v[90:91], v115 offset:17408
    v_mfma_f32_16x16x32_bf16 v[132:135], v[36:39], v[16:19], v[132:135]
    ds_read_b64_tr_b16 v[92:93], v115 offset:18432
    v_mfma_f32_16x16x32_bf16 v[136:139], v[40:43], v[16:19], v[136:139]
    ds_read_b64_tr_b16 v[94:95], v115 offset:19456
    buffer_load_dwordx4 v127, s[28:31], s54 offen offset:1024 lds
    v_mfma_f32_16x16x32_bf16 v[168:171], v[40:43], v[20:23], v[168:171]
    ds_read_b64_tr_b16 v[96:97], v116 offset:16384
    v_mfma_f32_16x16x32_bf16 v[200:203], v[40:43], v[24:27], v[200:203]
    ds_read_b64_tr_b16 v[98:99], v116 offset:17408
    v_mfma_f32_16x16x32_bf16 v[232:235], v[40:43], v[28:31], v[232:235]
    ds_read_b64_tr_b16 v[100:101], v116 offset:18432
    v_mfma_f32_16x16x32_bf16 v[236:239], v[44:47], v[28:31], v[236:239]
    ds_read_b64_tr_b16 v[102:103], v116 offset:19456
    v_mfma_f32_16x16x32_bf16 v[204:207], v[44:47], v[24:27], v[204:207]
    ds_read_b64_tr_b16 v[104:105], v117 offset:16384
    v_mfma_f32_16x16x32_bf16 v[172:175], v[44:47], v[20:23], v[172:175]
    ds_read_b64_tr_b16 v[106:107], v117 offset:17408
    buffer_load_dwordx4 v126, s[32:35], s54 offen offset:2048 lds
    v_mfma_f32_16x16x32_bf16 v[140:143], v[44:47], v[16:19], v[140:143]
    ds_read_b64_tr_b16 v[108:109], v117 offset:18432
    v_mfma_f32_16x16x32_bf16 v[144:147], v[48:51], v[16:19], v[144:147]
    ds_read_b64_tr_b16 v[110:111], v117 offset:19456
    v_mfma_f32_16x16x32_bf16 v[176:179], v[48:51], v[20:23], v[176:179]
    ds_read_b128 v[68:71], v113 offset:2048
    v_mfma_f32_16x16x32_bf16 v[208:211], v[48:51], v[24:27], v[208:211]
    ds_read_b128 v[72:75], v113 offset:4096
    v_mfma_f32_16x16x32_bf16 v[240:243], v[48:51], v[28:31], v[240:243]
    ds_read_b128 v[76:79], v113 offset:6144
    v_mfma_f32_16x16x32_bf16 v[244:247], v[52:55], v[28:31], v[244:247]
    buffer_load_dwordx4 v127, s[32:35], s54 offen offset:3072 lds
    v_xor_b32 v112, 0x8000, v112
    v_mfma_f32_16x16x32_bf16 v[212:215], v[52:55], v[24:27], v[212:215]
    s_add_u32 s54, s54, 458752
    s_add_u32 s53, s53, 128
    v_xor_b32 v113, 0x8000, v113
    v_mfma_f32_16x16x32_bf16 v[180:183], v[52:55], v[20:23], v[180:183]
    v_add_u32 v114, s61, v118
    v_mfma_f32_16x16x32_bf16 v[148:151], v[52:55], v[16:19], v[148:151]
    v_add_u32 v115, s61, v119
    v_mfma_f32_16x16x32_bf16 v[152:155], v[56:59], v[16:19], v[152:155]
    v_add_u32 v116, s61, v120
    v_mfma_f32_16x16x32_bf16 v[184:187], v[56:59], v[20:23], v[184:187]
    v_add_u32 v117, s61, v121
    v_mfma_f32_16x16x32_bf16 v[216:219], v[56:59], v[24:27], v[216:219]
    v_mfma_f32_16x16x32_bf16 v[248:251], v[56:59], v[28:31], v[248:251]
    v_mfma_f32_16x16x32_bf16 v[252:255], v[60:63], v[28:31], v[252:255]
    v_mfma_f32_16x16x32_bf16 v[220:223], v[60:63], v[24:27], v[220:223]
    v_mfma_f32_16x16x32_bf16 v[188:191], v[60:63], v[20:23], v[188:191]
    s_mov_b64 exec, s[94:95]
    buffer_load_dword v1, v0, s[96:99], s92 offen
    s_mov_b64 exec, -1
    s_add_u32 s92, s92, s93
    v_mfma_f32_16x16x32_bf16 v[156:159], v[60:63], v[16:19], v[156:159]
    s_add_u32 s58, s58, 1
    s_cmp_lt_u32 s58, 13
    s_cbranch_scc1 L_loop_n4
    s_mov_b32 m0, s56
    s_waitcnt vmcnt(5) lgkmcnt(0)
    s_barrier
    v_mfma_f32_16x16x32_bf16 v[128:131], v[80:83], v[64:67], v[128:131]
    ds_read_b128 v[16:19], v112 offset:0
    buffer_load_dwordx4 v122, s[24:27], s53 offen offset:0 lds
    v_mfma_f32_16x16x32_bf16 v[160:163], v[80:83], v[68:71], v[160:163]
    ds_read_b64_tr_b16 v[32:33], v114 offset:0
    v_mfma_f32_16x16x32_bf16 v[192:195], v[80:83], v[72:75], v[192:195]
    ds_read_b64_tr_b16 v[34:35], v114 offset:1024
    buffer_load_dwordx4 v123, s[24:27], s53 offen offset:1024 lds
    v_mfma_f32_16x16x32_bf16 v[224:227], v[80:83], v[76:79], v[224:227]
    ds_read_b64_tr_b16 v[36:37], v114 offset:2048
    v_mfma_f32_16x16x32_bf16 v[228:231], v[84:87], v[76:79], v[228:231]
    ds_read_b64_tr_b16 v[38:39], v114 offset:3072
    buffer_load_dwordx4 v124, s[24:27], s53 offen offset:2048 lds
    v_mfma_f32_16x16x32_bf16 v[196:199], v[84:87], v[72:75], v[196:199]
    ds_read_b64_tr_b16 v[40:41], v115 offset:0
    v_mfma_f32_16x16x32_bf16 v[164:167], v[84:87], v[68:71], v[164:167]
    ds_read_b64_tr_b16 v[42:43], v115 offset:1024
    buffer_load_dwordx4 v125, s[24:27], s53 offen offset:3072 lds
    v_mfma_f32_16x16x32_bf16 v[132:135], v[84:87], v[64:67], v[132:135]
    ds_read_b64_tr_b16 v[44:45], v115 offset:2048
    v_mfma_f32_16x16x32_bf16 v[136:139], v[88:91], v[64:67], v[136:139]
    ds_read_b64_tr_b16 v[46:47], v115 offset:3072
    v_mfma_f32_16x16x32_bf16 v[168:171], v[88:91], v[68:71], v[168:171]
    ds_read_b64_tr_b16 v[48:49], v116 offset:0
    s_and_b32 s60, s2, 63
    s_lshl_b32 s60, s60, 2
    s_lshr_b32 s64, s2, 6
    s_add_u32 s60, s60, s64
    s_mul_i32 s60, s60, 16512
    s_add_u32 s60, s60, 0x01400000
    s_lshl_b32 s64, s48, 11
    s_add_u32 s64, s64, s60
    buffer_store_dwordx4 v[4:7], v3, s[36:39], s64 offen sc1
    buffer_store_dwordx4 v[8:11], v3, s[36:39], s64 offen offset:1024 sc1
    s_lshl_b32 s62, s48, 2
    s_add_u32 s62, s62, s60
    s_add_u32 s62, s62, 16384
    s_mov_b64 exec, 1
    buffer_store_dword v12, v3, s[36:39], s62 offen sc1
    s_mov_b64 exec, -1
    s_nop 0
    v_mfma_f32_16x16x32_bf16 v[200:203], v[88:91], v[72:75], v[200:203]
    ds_read_b64_tr_b16 v[50:51], v116 offset:1024
    v_mfma_f32_16x16x32_bf16 v[232:235], v[88:91], v[76:79], v[232:235]
    ds_read_b64_tr_b16 v[52:53], v116 offset:2048
    v_mfma_f32_16x16x32_bf16 v[236:239], v[92:95], v[76:79], v[236:239]
    ds_read_b64_tr_b16 v[54:55], v116 offset:3072
    v_mfma_f32_16x16x32_bf16 v[204:207], v[92:95], v[72:75], v[204:207]
    ds_read_b64_tr_b16 v[56:57], v117 offset:0
    v_mfma_f32_16x16x32_bf16 v[172:175], v[92:95], v[68:71], v[172:175]
    ds_read_b64_tr_b16 v[58:59], v117 offset:1024
    v_mfma_f32_16x16x32_bf16 v[140:143], v[92:95], v[64:67], v[140:143]
    ds_read_b64_tr_b16 v[60:61], v117 offset:2048
    v_mfma_f32_16x16x32_bf16 v[144:147], v[96:99], v[64:67], v[144:147]
    ds_read_b64_tr_b16 v[62:63], v117 offset:3072
    v_mfma_f32_16x16x32_bf16 v[176:179], v[96:99], v[68:71], v[176:179]
    ds_read_b128 v[20:23], v112 offset:2048
    v_mfma_f32_16x16x32_bf16 v[208:211], v[96:99], v[72:75], v[208:211]
    ds_read_b128 v[24:27], v112 offset:4096
    v_mfma_f32_16x16x32_bf16 v[240:243], v[96:99], v[76:79], v[240:243]
    ds_read_b128 v[28:31], v112 offset:6144
    v_mfma_f32_16x16x32_bf16 v[244:247], v[100:103], v[76:79], v[244:247]
    s_xor_b32 s56, s56, 0x8000
    v_mfma_f32_16x16x32_bf16 v[212:215], v[100:103], v[72:75], v[212:215]
    v_mfma_f32_16x16x32_bf16 v[180:183], v[100:103], v[68:71], v[180:183]
    v_mfma_f32_16x16x32_bf16 v[148:151], v[100:103], v[64:67], v[148:151]
    v_mfma_f32_16x16x32_bf16 v[152:155], v[104:107], v[64:67], v[152:155]
    v_mfma_f32_16x16x32_bf16 v[184:187], v[104:107], v[68:71], v[184:187]
    v_mfma_f32_16x16x32_bf16 v[216:219], v[104:107], v[72:75], v[216:219]
    v_mfma_f32_16x16x32_bf16 v[248:251], v[104:107], v[76:79], v[248:251]
    v_mfma_f32_16x16x32_bf16 v[252:255], v[108:111], v[76:79], v[252:255]
    v_mfma_f32_16x16x32_bf16 v[220:223], v[108:111], v[72:75], v[220:223]
    v_mfma_f32_16x16x32_bf16 v[188:191], v[108:111], v[68:71], v[188:191]
    v_mfma_f32_16x16x32_bf16 v[156:159], v[108:111], v[64:67], v[156:159]
    s_waitcnt lgkmcnt(0)
    v_mfma_f32_16x16x32_bf16 v[128:131], v[32:35], v[16:19], v[128:131]
    ds_read_b128 v[64:67], v113 offset:0
    v_mfma_f32_16x16x32_bf16 v[160:163], v[32:35], v[20:23], v[160:163]
    ds_read_b64_tr_b16 v[80:81], v114 offset:16384
    v_mfma_f32_16x16x32_bf16 v[192:195], v[32:35], v[24:27], v[192:195]
    ds_read_b64_tr_b16 v[82:83], v114 offset:17408
    v_mfma_f32_16x16x32_bf16 v[224:227], v[32:35], v[28:31], v[224:227]
    ds_read_b64_tr_b16 v[84:85], v114 offset:18432
    s_add_u32 s60, s57, 32768
    s_cmp_ge_u32 s60, 98304
    s_cselect_b32 s57, 0, s60
    v_mfma_f32_16x16x32_bf16 v[228:231], v[36:39], v[28:31], v[228:231]
    ds_read_b64_tr_b16 v[86:87], v114 offset:19456
    v_mfma_f32_16x16x32_bf16 v[196:199], v[36:39], v[24:27], v[196:199]
    ds_read_b64_tr_b16 v[88:89], v115 offset:16384
    s_add_u32 s60, s57, 32768
    s_cmp_ge_u32 s60, 98304
    s_cselect_b32 s61, 0, s60
    v_mfma_f32_16x16x32_bf16 v[164:167], v[36:39], v[20:23], v[164:167]
    ds_read_b64_tr_b16 v[90:91], v115 offset:17408
    v_mfma_f32_16x16x32_bf16 v[132:135], v[36:39], v[16:19], v[132:135]
    ds_read_b64_tr_b16 v[92:93], v115 offset:18432
    v_mfma_f32_16x16x32_bf16 v[136:139], v[40:43], v[16:19], v[136:139]
    ds_read_b64_tr_b16 v[94:95], v115 offset:19456
    v_mfma_f32_16x16x32_bf16 v[168:171], v[40:43], v[20:23], v[168:171]
    ds_read_b64_tr_b16 v[96:97], v116 offset:16384
    v_mfma_f32_16x16x32_bf16 v[200:203], v[40:43], v[24:27], v[200:203]
    ds_read_b64_tr_b16 v[98:99], v116 offset:17408
    v_mfma_f32_16x16x32_bf16 v[232:235], v[40:43], v[28:31], v[232:235]
    ds_read_b64_tr_b16 v[100:101], v116 offset:18432
    v_mfma_f32_16x16x32_bf16 v[236:239], v[44:47], v[28:31], v[236:239]
    ds_read_b64_tr_b16 v[102:103], v116 offset:19456
    v_mfma_f32_16x16x32_bf16 v[204:207], v[44:47], v[24:27], v[204:207]
    ds_read_b64_tr_b16 v[104:105], v117 offset:16384
    v_mfma_f32_16x16x32_bf16 v[172:175], v[44:47], v[20:23], v[172:175]
    ds_read_b64_tr_b16 v[106:107], v117 offset:17408
    v_mfma_f32_16x16x32_bf16 v[140:143], v[44:47], v[16:19], v[140:143]
    ds_read_b64_tr_b16 v[108:109], v117 offset:18432
    v_mfma_f32_16x16x32_bf16 v[144:147], v[48:51], v[16:19], v[144:147]
    ds_read_b64_tr_b16 v[110:111], v117 offset:19456
    v_mfma_f32_16x16x32_bf16 v[176:179], v[48:51], v[20:23], v[176:179]
    ds_read_b128 v[68:71], v113 offset:2048
    v_mfma_f32_16x16x32_bf16 v[208:211], v[48:51], v[24:27], v[208:211]
    ds_read_b128 v[72:75], v113 offset:4096
    v_mfma_f32_16x16x32_bf16 v[240:243], v[48:51], v[28:31], v[240:243]
    ds_read_b128 v[76:79], v113 offset:6144
    v_mfma_f32_16x16x32_bf16 v[244:247], v[52:55], v[28:31], v[244:247]
    v_xor_b32 v112, 0x8000, v112
    v_mfma_f32_16x16x32_bf16 v[212:215], v[52:55], v[24:27], v[212:215]
    v_xor_b32 v113, 0x8000, v113
    v_mfma_f32_16x16x32_bf16 v[180:183], v[52:55], v[20:23], v[180:183]
    v_add_u32 v114, s61, v118
    v_mfma_f32_16x16x32_bf16 v[148:151], v[52:55], v[16:19], v[148:151]
    v_add_u32 v115, s61, v119
    v_mfma_f32_16x16x32_bf16 v[152:155], v[56:59], v[16:19], v[152:155]
    v_add_u32 v116, s61, v120
    v_mfma_f32_16x16x32_bf16 v[184:187], v[56:59], v[20:23], v[184:187]
    v_add_u32 v117, s61, v121
    v_mfma_f32_16x16x32_bf16 v[216:219], v[56:59], v[24:27], v[216:219]
    v_mfma_f32_16x16x32_bf16 v[248:251], v[56:59], v[28:31], v[248:251]
    v_mfma_f32_16x16x32_bf16 v[252:255], v[60:63], v[28:31], v[252:255]
    v_mfma_f32_16x16x32_bf16 v[220:223], v[60:63], v[24:27], v[220:223]
    s_mov_b32 s40, s20
    s_and_b32 s41, s21, 0xffff
    s_mov_b32 s42, 0x00700000
    s_mov_b32 s43, 0x20000
    s_mul_i32 s62, s2, 28672
    s_mul_i32 s63, s48, 3584
    s_add_u32 s62, s62, s63
    v_lshlrev_b32 v0, 7, v2
    s_mov_b64 exec, 0xfffffff
    buffer_load_dword v1, v0, s[40:43], s62 offen
    s_mov_b64 exec, -1
    v_mfma_f32_16x16x32_bf16 v[188:191], v[60:63], v[20:23], v[188:191]
    v_mfma_f32_16x16x32_bf16 v[156:159], v[60:63], v[16:19], v[156:159]
    s_mov_b32 m0, s56
    s_waitcnt vmcnt(4) lgkmcnt(0)
    s_barrier
    v_mfma_f32_16x16x32_bf16 v[128:131], v[80:83], v[64:67], v[128:131]
    ds_read_b128 v[16:19], v112 offset:0
    v_mfma_f32_16x16x32_bf16 v[160:163], v[80:83], v[68:71], v[160:163]
    ds_read_b64_tr_b16 v[32:33], v114 offset:0
    v_mfma_f32_16x16x32_bf16 v[192:195], v[80:83], v[72:75], v[192:195]
    ds_read_b64_tr_b16 v[34:35], v114 offset:1024
    v_mfma_f32_16x16x32_bf16 v[224:227], v[80:83], v[76:79], v[224:227]
    ds_read_b64_tr_b16 v[36:37], v114 offset:2048
    v_mfma_f32_16x16x32_bf16 v[228:231], v[84:87], v[76:79], v[228:231]
    ds_read_b64_tr_b16 v[38:39], v114 offset:3072
    v_mfma_f32_16x16x32_bf16 v[196:199], v[84:87], v[72:75], v[196:199]
    ds_read_b64_tr_b16 v[40:41], v115 offset:0
    v_mfma_f32_16x16x32_bf16 v[164:167], v[84:87], v[68:71], v[164:167]
    ds_read_b64_tr_b16 v[42:43], v115 offset:1024
    v_mfma_f32_16x16x32_bf16 v[132:135], v[84:87], v[64:67], v[132:135]
    ds_read_b64_tr_b16 v[44:45], v115 offset:2048
    v_mfma_f32_16x16x32_bf16 v[136:139], v[88:91], v[64:67], v[136:139]
    ds_read_b64_tr_b16 v[46:47], v115 offset:3072
    v_mfma_f32_16x16x32_bf16 v[168:171], v[88:91], v[68:71], v[168:171]
    ds_read_b64_tr_b16 v[48:49], v116 offset:0
    v_mfma_f32_16x16x32_bf16 v[200:203], v[88:91], v[72:75], v[200:203]
    ds_read_b64_tr_b16 v[50:51], v116 offset:1024
    v_mov_b32 v14, 0xc0135761
    v_mov_b32 v15, 0xc0135761
    s_mov_b32 s60, 0xbdd2d3e8
    s_mov_b32 s61, 0xbdd2d3e8
    s_mov_b32 s68, 0xffff0000
    s_mov_b32 s69, 0xffff0000
    v_mfma_f32_16x16x32_bf16 v[232:235], v[88:91], v[76:79], v[232:235]
    ds_read_b64_tr_b16 v[52:53], v116 offset:2048
    s_mul_i32 s71, s50, 458752
    s_lshl_b32 s62, s49, 13
    s_and_b32 s63, s48, 3
    s_lshl_b32 s63, s63, 11
    s_add_u32 s62, s62, s63
    s_add_u32 s62, s62, s71
    v_mfma_f32_16x16x32_bf16 v[236:239], v[92:95], v[76:79], v[236:239]
    ds_read_b64_tr_b16 v[54:55], v116 offset:3072
    s_add_u32 s64, s62, 0x00000000
    v_mfma_f32_16x16x32_bf16 v[204:207], v[92:95], v[72:75], v[204:207]
    ds_read_b64_tr_b16 v[56:57], v117 offset:0
    s_add_u32 s65, s64, 65536
    v_mfma_f32_16x16x32_bf16 v[172:175], v[92:95], v[68:71], v[172:175]
    ds_read_b64_tr_b16 v[58:59], v117 offset:1024
    s_add_u32 s66, s64, 131072
    v_mfma_f32_16x16x32_bf16 v[140:143], v[92:95], v[64:67], v[140:143]
    ds_read_b64_tr_b16 v[60:61], v117 offset:2048
    s_add_u32 s67, s64, 196608
    v_mfma_f32_16x16x32_bf16 v[144:147], v[96:99], v[64:67], v[144:147]
    ds_read_b64_tr_b16 v[62:63], v117 offset:3072
    v_mfma_f32_16x16x32_bf16 v[176:179], v[96:99], v[68:71], v[176:179]
    ds_read_b128 v[20:23], v112 offset:2048
    v_mfma_f32_16x16x32_bf16 v[208:211], v[96:99], v[72:75], v[208:211]
    ds_read_b128 v[24:27], v112 offset:4096
    v_mfma_f32_16x16x32_bf16 v[240:243], v[96:99], v[76:79], v[240:243]
    ds_read_b128 v[28:31], v112 offset:6144
    v_mfma_f32_16x16x32_bf16 v[244:247], v[100:103], v[76:79], v[244:247]
    v_mfma_f32_16x16x32_bf16 v[212:215], v[100:103], v[72:75], v[212:215]
    v_mfma_f32_16x16x32_bf16 v[180:183], v[100:103], v[68:71], v[180:183]
    v_mfma_f32_16x16x32_bf16 v[148:151], v[100:103], v[64:67], v[148:151]
    v_mfma_f32_16x16x32_bf16 v[152:155], v[104:107], v[64:67], v[152:155]
    v_mfma_f32_16x16x32_bf16 v[184:187], v[104:107], v[68:71], v[184:187]
    v_mfma_f32_16x16x32_bf16 v[216:219], v[104:107], v[72:75], v[216:219]
    v_mfma_f32_16x16x32_bf16 v[248:251], v[104:107], v[76:79], v[248:251]
    v_mfma_f32_16x16x32_bf16 v[252:255], v[108:111], v[76:79], v[252:255]
    v_mfma_f32_16x16x32_bf16 v[220:223], v[108:111], v[72:75], v[220:223]
    v_mfma_f32_16x16x32_bf16 v[188:191], v[108:111], v[68:71], v[188:191]
    v_mfma_f32_16x16x32_bf16 v[156:159], v[108:111], v[64:67], v[156:159]
    s_waitcnt lgkmcnt(0)
    v_mfma_f32_16x16x32_bf16 v[128:131], v[32:35], v[16:19], v[128:131]
    ds_read_b128 v[64:67], v113 offset:0
    ds_read_b64_tr_b16 v[80:81], v114 offset:16384
    v_mfma_f32_16x16x32_bf16 v[132:135], v[36:39], v[16:19], v[132:135]
    ds_read_b64_tr_b16 v[82:83], v114 offset:17408
    ds_read_b64_tr_b16 v[84:85], v114 offset:18432
    v_mfma_f32_16x16x32_bf16 v[136:139], v[40:43], v[16:19], v[136:139]
    ds_read_b64_tr_b16 v[86:87], v114 offset:19456
    ds_read_b64_tr_b16 v[88:89], v115 offset:16384
    v_mfma_f32_16x16x32_bf16 v[140:143], v[44:47], v[16:19], v[140:143]
    ds_read_b64_tr_b16 v[90:91], v115 offset:17408
    ds_read_b64_tr_b16 v[92:93], v115 offset:18432
    v_mfma_f32_16x16x32_bf16 v[144:147], v[48:51], v[16:19], v[144:147]
    ds_read_b64_tr_b16 v[94:95], v115 offset:19456
    ds_read_b64_tr_b16 v[96:97], v116 offset:16384
    v_mfma_f32_16x16x32_bf16 v[148:151], v[52:55], v[16:19], v[148:151]
    ds_read_b64_tr_b16 v[98:99], v116 offset:17408
    ds_read_b64_tr_b16 v[100:101], v116 offset:18432
    v_mfma_f32_16x16x32_bf16 v[152:155], v[56:59], v[16:19], v[152:155]
    ds_read_b64_tr_b16 v[102:103], v116 offset:19456
    ds_read_b64_tr_b16 v[104:105], v117 offset:16384
    v_mfma_f32_16x16x32_bf16 v[156:159], v[60:63], v[16:19], v[156:159]
    ds_read_b64_tr_b16 v[106:107], v117 offset:17408
    ds_read_b64_tr_b16 v[108:109], v117 offset:18432
    v_mfma_f32_16x16x32_bf16 v[188:191], v[60:63], v[20:23], v[188:191]
    ds_read_b64_tr_b16 v[110:111], v117 offset:19456
    ds_read_b128 v[68:71], v113 offset:2048
    v_mfma_f32_16x16x32_bf16 v[184:187], v[56:59], v[20:23], v[184:187]
    ds_read_b128 v[72:75], v113 offset:4096
    ds_read_b128 v[76:79], v113 offset:6144
    v_mfma_f32_16x16x32_bf16 v[180:183], v[52:55], v[20:23], v[180:183]
    v_mfma_f32_16x16x32_bf16 v[176:179], v[48:51], v[20:23], v[176:179]
    v_mfma_f32_16x16x32_bf16 v[172:175], v[44:47], v[20:23], v[172:175]
    v_mfma_f32_16x16x32_bf16 v[168:171], v[40:43], v[20:23], v[168:171]
    v_mfma_f32_16x16x32_bf16 v[164:167], v[36:39], v[20:23], v[164:167]
    v_mfma_f32_16x16x32_bf16 v[160:163], v[32:35], v[20:23], v[160:163]
    s_waitcnt vmcnt(1) lgkmcnt(0)
    s_barrier
    v_mfma_f32_16x16x32_bf16 v[128:131], v[80:83], v[64:67], v[128:131]
    v_mfma_f32_16x16x32_bf16 v[132:135], v[84:87], v[64:67], v[132:135]
    v_mfma_f32_16x16x32_bf16 v[136:139], v[88:91], v[64:67], v[136:139]
    v_mfma_f32_16x16x32_bf16 v[140:143], v[92:95], v[64:67], v[140:143]
    v_mfma_f32_16x16x32_bf16 v[144:147], v[96:99], v[64:67], v[144:147]
    v_mfma_f32_16x16x32_bf16 v[148:151], v[100:103], v[64:67], v[148:151]
    v_mfma_f32_16x16x32_bf16 v[152:155], v[104:107], v[64:67], v[152:155]
    v_mfma_f32_16x16x32_bf16 v[156:159], v[108:111], v[64:67], v[156:159]
    v_mfma_f32_16x16x32_bf16 v[188:191], v[108:111], v[68:71], v[188:191]
    v_mfma_f32_16x16x32_bf16 v[184:187], v[104:107], v[68:71], v[184:187]
    v_mfma_f32_16x16x32_bf16 v[180:183], v[100:103], v[68:71], v[180:183]
    v_mfma_f32_16x16x32_bf16 v[176:179], v[96:99], v[68:71], v[176:179]
    s_nop 3
    v_pk_mul_f32 v[4:5], v[128:129], v[128:129]
    v_pk_mul_f32 v[6:7], v[130:131], v[130:131]
    v_pk_mul_f32 v[8:9], v[136:137], v[136:137]
    v_pk_mul_f32 v[10:11], v[138:139], v[138:139]
    v_pk_fma_f32 v[4:5], v[4:5], s[60:61], v[14:15]
    v_pk_fma_f32 v[6:7], v[6:7], s[60:61], v[14:15]
    v_mfma_f32_16x16x32_bf16 v[172:175], v[92:95], v[68:71], v[172:175]
    v_pk_fma_f32 v[8:9], v[8:9], s[60:61], v[14:15]
    v_pk_fma_f32 v[10:11], v[10:11], s[60:61], v[14:15]
    v_pk_mul_f32 v[4:5], v[4:5], v[128:129]
    v_pk_mul_f32 v[6:7], v[6:7], v[130:131]
    v_pk_mul_f32 v[8:9], v[8:9], v[136:137]
    v_pk_mul_f32 v[10:11], v[10:11], v[138:139]
    v_mfma_f32_16x16x32_bf16 v[168:171], v[88:91], v[68:71], v[168:171]
    v_exp_f32 v4, v4
    v_exp_f32 v5, v5
    v_exp_f32 v6, v6
    v_exp_f32 v7, v7
    v_exp_f32 v8, v8
    v_exp_f32 v9, v9
    v_mfma_f32_16x16x32_bf16 v[164:167], v[84:87], v[68:71], v[164:167]
    v_exp_f32 v10, v10
    v_exp_f32 v11, v11
    v_pk_mul_f32 v[132:133], v[128:129], v[132:133]
    v_pk_mul_f32 v[134:135], v[130:131], v[134:135]
    v_pk_mul_f32 v[140:141], v[136:137], v[140:141]
    v_pk_mul_f32 v[142:143], v[138:139], v[142:143]
    v_mfma_f32_16x16x32_bf16 v[160:163], v[80:83], v[68:71], v[160:163]
    v_pk_add_f32 v[4:5], v[4:5], 1.0 op_sel_hi:[1,0]
    v_pk_add_f32 v[6:7], v[6:7], 1.0 op_sel_hi:[1,0]
    v_pk_add_f32 v[8:9], v[8:9], 1.0 op_sel_hi:[1,0]
    v_pk_add_f32 v[10:11], v[10:11], 1.0 op_sel_hi:[1,0]
    v_rcp_f32 v4, v4
    v_rcp_f32 v5, v5
    v_mfma_f32_16x16x32_bf16 v[192:195], v[32:35], v[24:27], v[192:195]
    v_rcp_f32 v6, v6
    v_rcp_f32 v7, v7
    v_rcp_f32 v8, v8
    v_rcp_f32 v9, v9
    v_rcp_f32 v10, v10
    v_rcp_f32 v11, v11
    v_mfma_f32_16x16x32_bf16 v[196:199], v[36:39], v[24:27], v[196:199]
    s_nop 0
    v_pk_mul_f32 v[132:133], v[132:133], v[4:5]
    v_pk_mul_f32 v[134:135], v[134:135], v[6:7]
    v_pk_mul_f32 v[140:141], v[140:141], v[8:9]
    v_pk_mul_f32 v[142:143], v[142:143], v[10:11]
    v_cvt_pk_bf16_f32 v128, v132, v133
    v_mfma_f32_16x16x32_bf16 v[200:203], v[40:43], v[24:27], v[200:203]
    v_cvt_pk_bf16_f32 v129, v134, v135
    v_cvt_pk_bf16_f32 v136, v140, v141
    v_cvt_pk_bf16_f32 v137, v142, v143
    v_pk_mul_f32 v[120:121], v[144:145], v[144:145]
    v_pk_mul_f32 v[122:123], v[146:147], v[146:147]
    v_pk_mul_f32 v[124:125], v[152:153], v[152:153]
    v_mfma_f32_16x16x32_bf16 v[204:207], v[44:47], v[24:27], v[204:207]
    v_pk_mul_f32 v[126:127], v[154:155], v[154:155]
    v_pk_fma_f32 v[120:121], v[120:121], s[60:61], v[14:15]
    v_pk_fma_f32 v[122:123], v[122:123], s[60:61], v[14:15]
    v_pk_fma_f32 v[124:125], v[124:125], s[60:61], v[14:15]
    v_pk_fma_f32 v[126:127], v[126:127], s[60:61], v[14:15]
    v_pk_mul_f32 v[120:121], v[120:121], v[144:145]
    v_mfma_f32_16x16x32_bf16 v[208:211], v[48:51], v[24:27], v[208:211]
    v_pk_mul_f32 v[122:123], v[122:123], v[146:147]
    v_pk_mul_f32 v[124:125], v[124:125], v[152:153]
    v_pk_mul_f32 v[126:127], v[126:127], v[154:155]
    v_exp_f32 v120, v120
    v_exp_f32 v121, v121
    v_exp_f32 v122, v122
    v_mfma_f32_16x16x32_bf16 v[212:215], v[52:55], v[24:27], v[212:215]
    v_exp_f32 v123, v123
    v_exp_f32 v124, v124
    v_exp_f32 v125, v125
    v_exp_f32 v126, v126
    v_exp_f32 v127, v127
    v_pk_mul_f32 v[148:149], v[144:145], v[148:149]
    v_mfma_f32_16x16x32_bf16 v[216:219], v[56:59], v[24:27], v[216:219]
    v_pk_mul_f32 v[150:151], v[146:147], v[150:151]
    v_pk_mul_f32 v[156:157], v[152:153], v[156:157]
    v_pk_mul_f32 v[158:159], v[154:155], v[158:159]
    v_pk_add_f32 v[120:121], v[120:121], 1.0 op_sel_hi:[1,0]
    v_pk_add_f32 v[122:123], v[122:123], 1.0 op_sel_hi:[1,0]
    v_pk_add_f32 v[124:125], v[124:125], 1.0 op_sel_hi:[1,0]
    v_mfma_f32_16x16x32_bf16 v[220:223], v[60:63], v[24:27], v[220:223]
    v_pk_add_f32 v[126:127], v[126:127], 1.0 op_sel_hi:[1,0]
    v_rcp_f32 v120, v120
    v_rcp_f32 v121, v121
    v_rcp_f32 v122, v122
    v_rcp_f32 v123, v123
    v_rcp_f32 v124, v124
    v_rcp_f32 v125, v125
    v_rcp_f32 v126, v126
    v_rcp_f32 v127, v127
    s_nop 0
    v_pk_mul_f32 v[148:149], v[148:149], v[120:121]
    v_pk_mul_f32 v[150:151], v[150:151], v[122:123]
    v_pk_mul_f32 v[156:157], v[156:157], v[124:125]
    v_pk_mul_f32 v[158:159], v[158:159], v[126:127]
    v_cvt_pk_bf16_f32 v144, v148, v149
    v_cvt_pk_bf16_f32 v145, v150, v151
    v_cvt_pk_bf16_f32 v152, v156, v157
    v_cvt_pk_bf16_f32 v153, v158, v159
    v_mfma_f32_16x16x32_bf16 v[192:195], v[80:83], v[72:75], v[192:195]
    v_mfma_f32_16x16x32_bf16 v[196:199], v[84:87], v[72:75], v[196:199]
    v_mfma_f32_16x16x32_bf16 v[200:203], v[88:91], v[72:75], v[200:203]
    v_mfma_f32_16x16x32_bf16 v[204:207], v[92:95], v[72:75], v[204:207]
    s_nop 3
    v_pk_mul_f32 v[4:5], v[160:161], v[160:161]
    v_pk_mul_f32 v[6:7], v[162:163], v[162:163]
    v_pk_mul_f32 v[8:9], v[168:169], v[168:169]
    v_pk_mul_f32 v[10:11], v[170:171], v[170:171]
    v_pk_fma_f32 v[4:5], v[4:5], s[60:61], v[14:15]
    v_pk_fma_f32 v[6:7], v[6:7], s[60:61], v[14:15]
    v_pk_fma_f32 v[8:9], v[8:9], s[60:61], v[14:15]
    v_mfma_f32_16x16x32_bf16 v[208:211], v[96:99], v[72:75], v[208:211]
    v_pk_fma_f32 v[10:11], v[10:11], s[60:61], v[14:15]
    v_pk_mul_f32 v[4:5], v[4:5], v[160:161]
    v_pk_mul_f32 v[6:7], v[6:7], v[162:163]
    v_pk_mul_f32 v[8:9], v[8:9], v[168:169]
    v_pk_mul_f32 v[10:11], v[10:11], v[170:171]
    v_exp_f32 v4, v4
    v_exp_f32 v5, v5
    v_mfma_f32_16x16x32_bf16 v[212:215], v[100:103], v[72:75], v[212:215]
    v_exp_f32 v6, v6
    v_exp_f32 v7, v7
    v_exp_f32 v8, v8
    v_exp_f32 v9, v9
    v_exp_f32 v10, v10
    v_exp_f32 v11, v11
    v_pk_mul_f32 v[164:165], v[160:161], v[164:165]
    v_mfma_f32_16x16x32_bf16 v[216:219], v[104:107], v[72:75], v[216:219]
    v_pk_mul_f32 v[166:167], v[162:163], v[166:167]
    v_pk_mul_f32 v[172:173], v[168:169], v[172:173]
    v_pk_mul_f32 v[174:175], v[170:171], v[174:175]
    v_pk_add_f32 v[4:5], v[4:5], 1.0 op_sel_hi:[1,0]
    v_pk_add_f32 v[6:7], v[6:7], 1.0 op_sel_hi:[1,0]
    v_pk_add_f32 v[8:9], v[8:9], 1.0 op_sel_hi:[1,0]
    v_pk_add_f32 v[10:11], v[10:11], 1.0 op_sel_hi:[1,0]
    v_mfma_f32_16x16x32_bf16 v[220:223], v[108:111], v[72:75], v[220:223]
    v_rcp_f32 v4, v4
    v_rcp_f32 v5, v5
    v_rcp_f32 v6, v6
    v_rcp_f32 v7, v7
    v_rcp_f32 v8, v8
    v_rcp_f32 v9, v9
    v_rcp_f32 v10, v10
    v_mfma_f32_16x16x32_bf16 v[252:255], v[60:63], v[28:31], v[252:255]
    v_rcp_f32 v11, v11
    s_nop 0
    v_pk_mul_f32 v[164:165], v[164:165], v[4:5]
    v_pk_mul_f32 v[166:167], v[166:167], v[6:7]
    v_pk_mul_f32 v[172:173], v[172:173], v[8:9]
    v_pk_mul_f32 v[174:175], v[174:175], v[10:11]
    v_cvt_pk_bf16_f32 v130, v164, v165
    v_mfma_f32_16x16x32_bf16 v[248:251], v[56:59], v[28:31], v[248:251]
    v_cvt_pk_bf16_f32 v131, v166, v167
    s_mov_b64 exec, s[68:69]
    v_swap_b32 v128, v130
    v_swap_b32 v129, v131
    s_mov_b64 exec, -1
    buffer_store_dwordx4 v[128:131], v3, s[36:39], s64 offen offset:0 sc1
    v_cvt_pk_bf16_f32 v138, v172, v173
    v_cvt_pk_bf16_f32 v139, v174, v175
    s_mov_b64 exec, s[68:69]
    v_swap_b32 v136, v138
    v_swap_b32 v137, v139
    s_mov_b64 exec, -1
    buffer_store_dwordx4 v[136:139], v3, s[36:39], s65 offen offset:0 sc1
    v_mfma_f32_16x16x32_bf16 v[244:247], v[52:55], v[28:31], v[244:247]
    v_pk_mul_f32 v[120:121], v[176:177], v[176:177]
    v_pk_mul_f32 v[122:123], v[178:179], v[178:179]
    v_pk_mul_f32 v[124:125], v[184:185], v[184:185]
    v_pk_mul_f32 v[126:127], v[186:187], v[186:187]
    v_pk_fma_f32 v[120:121], v[120:121], s[60:61], v[14:15]
    v_pk_fma_f32 v[122:123], v[122:123], s[60:61], v[14:15]
    v_pk_fma_f32 v[124:125], v[124:125], s[60:61], v[14:15]
    v_mfma_f32_16x16x32_bf16 v[240:243], v[48:51], v[28:31], v[240:243]
    v_pk_fma_f32 v[126:127], v[126:127], s[60:61], v[14:15]
    v_pk_mul_f32 v[120:121], v[120:121], v[176:177]
    v_pk_mul_f32 v[122:123], v[122:123], v[178:179]
    v_pk_mul_f32 v[124:125], v[124:125], v[184:185]
    v_pk_mul_f32 v[126:127], v[126:127], v[186:187]
    v_exp_f32 v120, v120
    v_exp_f32 v121, v121
    v_mfma_f32_16x16x32_bf16 v[236:239], v[44:47], v[28:31], v[236:239]
    v_exp_f32 v122, v122
    v_exp_f32 v123, v123
    v_exp_f32 v124, v124
    v_exp_f32 v125, v125
    v_exp_f32 v126, v126
    v_exp_f32 v127, v127
    v_pk_mul_f32 v[180:181], v[176:177], v[180:181]
    v_mfma_f32_16x16x32_bf16 v[232:235], v[40:43], v[28:31], v[232:235]
    v_pk_mul_f32 v[182:183], v[178:179], v[182:183]
    v_pk_mul_f32 v[188:189], v[184:185], v[188:189]
    v_pk_mul_f32 v[190:191], v[186:187], v[190:191]
    v_pk_add_f32 v[120:121], v[120:121], 1.0 op_sel_hi:[1,0]
    v_pk_add_f32 v[122:123], v[122:123], 1.0 op_sel_hi:[1,0]
    v_pk_add_f32 v[124:125], v[124:125], 1.0 op_sel_hi:[1,0]
    v_pk_add_f32 v[126:127], v[126:127], 1.0 op_sel_hi:[1,0]
    v_mfma_f32_16x16x32_bf16 v[228:231], v[36:39], v[28:31], v[228:231]
    v_rcp_f32 v120, v120
    v_rcp_f32 v121, v121
    v_rcp_f32 v122, v122
    v_rcp_f32 v123, v123
    v_rcp_f32 v124, v124
    v_rcp_f32 v125, v125
    v_rcp_f32 v126, v126
    v_mfma_f32_16x16x32_bf16 v[224:227], v[32:35], v[28:31], v[224:227]
    v_rcp_f32 v127, v127
    s_nop 0
    v_pk_mul_f32 v[180:181], v[180:181], v[120:121]
    v_pk_mul_f32 v[182:183], v[182:183], v[122:123]
    v_pk_mul_f32 v[188:189], v[188:189], v[124:125]
    v_pk_mul_f32 v[190:191], v[190:191], v[126:127]
    v_cvt_pk_bf16_f32 v146, v180, v181
    v_cvt_pk_bf16_f32 v147, v182, v183
    s_mov_b64 exec, s[68:69]
    v_swap_b32 v144, v146
    v_swap_b32 v145, v147
    s_mov_b64 exec, -1
    buffer_store_dwordx4 v[144:147], v3, s[36:39], s66 offen offset:0 sc1
    v_cvt_pk_bf16_f32 v154, v188, v189
    v_cvt_pk_bf16_f32 v155, v190, v191
    s_mov_b64 exec, s[68:69]
    v_swap_b32 v152, v154
    v_swap_b32 v153, v155
    s_mov_b64 exec, -1
    buffer_store_dwordx4 v[152:155], v3, s[36:39], s67 offen offset:0 sc1
    v_mfma_f32_16x16x32_bf16 v[252:255], v[108:111], v[76:79], v[252:255]
    v_mfma_f32_16x16x32_bf16 v[248:251], v[104:107], v[76:79], v[248:251]
    v_mfma_f32_16x16x32_bf16 v[244:247], v[100:103], v[76:79], v[244:247]
    v_mfma_f32_16x16x32_bf16 v[240:243], v[96:99], v[76:79], v[240:243]
    s_nop 3
    v_pk_mul_f32 v[4:5], v[192:193], v[192:193]
    v_pk_mul_f32 v[6:7], v[194:195], v[194:195]
    v_pk_mul_f32 v[8:9], v[200:201], v[200:201]
    v_pk_mul_f32 v[10:11], v[202:203], v[202:203]
    v_pk_fma_f32 v[4:5], v[4:5], s[60:61], v[14:15]
    v_pk_fma_f32 v[6:7], v[6:7], s[60:61], v[14:15]
    v_pk_fma_f32 v[8:9], v[8:9], s[60:61], v[14:15]
    v_pk_fma_f32 v[10:11], v[10:11], s[60:61], v[14:15]
    v_pk_mul_f32 v[4:5], v[4:5], v[192:193]
    v_pk_mul_f32 v[6:7], v[6:7], v[194:195]
    v_pk_mul_f32 v[8:9], v[8:9], v[200:201]
    v_pk_mul_f32 v[10:11], v[10:11], v[202:203]
    v_exp_f32 v4, v4
    v_exp_f32 v5, v5
    v_exp_f32 v6, v6
    v_exp_f32 v7, v7
    v_exp_f32 v8, v8
    v_exp_f32 v9, v9
    v_mfma_f32_16x16x32_bf16 v[236:239], v[92:95], v[76:79], v[236:239]
    v_exp_f32 v10, v10
    v_exp_f32 v11, v11
    v_pk_mul_f32 v[196:197], v[192:193], v[196:197]
    v_pk_mul_f32 v[198:199], v[194:195], v[198:199]
    v_pk_mul_f32 v[204:205], v[200:201], v[204:205]
    v_pk_mul_f32 v[206:207], v[202:203], v[206:207]
    v_pk_add_f32 v[4:5], v[4:5], 1.0 op_sel_hi:[1,0]
    v_pk_add_f32 v[6:7], v[6:7], 1.0 op_sel_hi:[1,0]
    v_pk_add_f32 v[8:9], v[8:9], 1.0 op_sel_hi:[1,0]
    v_pk_add_f32 v[10:11], v[10:11], 1.0 op_sel_hi:[1,0]
    v_rcp_f32 v4, v4
    v_rcp_f32 v5, v5
    v_rcp_f32 v6, v6
    v_rcp_f32 v7, v7
    v_rcp_f32 v8, v8
    v_rcp_f32 v9, v9
    v_rcp_f32 v10, v10
    v_rcp_f32 v11, v11
    v_mfma_f32_16x16x32_bf16 v[232:235], v[88:91], v[76:79], v[232:235]
    s_nop 0
    v_pk_mul_f32 v[196:197], v[196:197], v[4:5]
    v_pk_mul_f32 v[198:199], v[198:199], v[6:7]
    v_pk_mul_f32 v[204:205], v[204:205], v[8:9]
    v_pk_mul_f32 v[206:207], v[206:207], v[10:11]
    v_cvt_pk_bf16_f32 v192, v196, v197
    v_cvt_pk_bf16_f32 v193, v198, v199
    v_cvt_pk_bf16_f32 v200, v204, v205
    v_cvt_pk_bf16_f32 v201, v206, v207
    v_pk_mul_f32 v[120:121], v[208:209], v[208:209]
    v_pk_mul_f32 v[122:123], v[210:211], v[210:211]
    v_pk_mul_f32 v[124:125], v[216:217], v[216:217]
    v_pk_mul_f32 v[126:127], v[218:219], v[218:219]
    v_pk_fma_f32 v[120:121], v[120:121], s[60:61], v[14:15]
    v_pk_fma_f32 v[122:123], v[122:123], s[60:61], v[14:15]
    v_pk_fma_f32 v[124:125], v[124:125], s[60:61], v[14:15]
    v_pk_fma_f32 v[126:127], v[126:127], s[60:61], v[14:15]
    v_pk_mul_f32 v[120:121], v[120:121], v[208:209]
    v_mfma_f32_16x16x32_bf16 v[228:231], v[84:87], v[76:79], v[228:231]
    v_pk_mul_f32 v[122:123], v[122:123], v[210:211]
    v_pk_mul_f32 v[124:125], v[124:125], v[216:217]
    v_pk_mul_f32 v[126:127], v[126:127], v[218:219]
    v_exp_f32 v120, v120
    v_exp_f32 v121, v121
    v_exp_f32 v122, v122
    v_exp_f32 v123, v123
    v_exp_f32 v124, v124
    v_exp_f32 v125, v125
    v_exp_f32 v126, v126
    v_exp_f32 v127, v127
    v_pk_mul_f32 v[212:213], v[208:209], v[212:213]
    v_pk_mul_f32 v[214:215], v[210:211], v[214:215]
    v_pk_mul_f32 v[220:221], v[216:217], v[220:221]
    v_pk_mul_f32 v[222:223], v[218:219], v[222:223]
    v_pk_add_f32 v[120:121], v[120:121], 1.0 op_sel_hi:[1,0]
    v_pk_add_f32 v[122:123], v[122:123], 1.0 op_sel_hi:[1,0]
    v_pk_add_f32 v[124:125], v[124:125], 1.0 op_sel_hi:[1,0]
    v_mfma_f32_16x16x32_bf16 v[224:227], v[80:83], v[76:79], v[224:227]
    v_pk_add_f32 v[126:127], v[126:127], 1.0 op_sel_hi:[1,0]
    v_rcp_f32 v120, v120
    v_rcp_f32 v121, v121
    v_rcp_f32 v122, v122
    v_rcp_f32 v123, v123
    v_rcp_f32 v124, v124
    v_rcp_f32 v125, v125
    v_rcp_f32 v126, v126
    v_rcp_f32 v127, v127
    s_nop 0
    v_pk_mul_f32 v[212:213], v[212:213], v[120:121]
    v_pk_mul_f32 v[214:215], v[214:215], v[122:123]
    v_pk_mul_f32 v[220:221], v[220:221], v[124:125]
    v_pk_mul_f32 v[222:223], v[222:223], v[126:127]
    v_cvt_pk_bf16_f32 v208, v212, v213
    v_cvt_pk_bf16_f32 v209, v214, v215
    v_cvt_pk_bf16_f32 v216, v220, v221
    v_cvt_pk_bf16_f32 v217, v222, v223
    s_mov_b32 s63, 0x01912000
    buffer_load_dwordx4 v[116:119], v3, s[36:39], s63 offen sc1
    s_nop 7
    v_pk_mul_f32 v[4:5], v[224:225], v[224:225]
    v_pk_mul_f32 v[6:7], v[226:227], v[226:227]
    v_pk_mul_f32 v[8:9], v[232:233], v[232:233]
    v_pk_mul_f32 v[10:11], v[234:235], v[234:235]
    v_pk_fma_f32 v[4:5], v[4:5], s[60:61], v[14:15]
    v_pk_fma_f32 v[6:7], v[6:7], s[60:61], v[14:15]
    v_pk_fma_f32 v[8:9], v[8:9], s[60:61], v[14:15]
    v_pk_fma_f32 v[10:11], v[10:11], s[60:61], v[14:15]
    v_pk_mul_f32 v[4:5], v[4:5], v[224:225]
    v_pk_mul_f32 v[6:7], v[6:7], v[226:227]
    v_pk_mul_f32 v[8:9], v[8:9], v[232:233]
    v_pk_mul_f32 v[10:11], v[10:11], v[234:235]
    v_exp_f32 v4, v4
    v_exp_f32 v5, v5
    v_exp_f32 v6, v6
    v_exp_f32 v7, v7
    v_exp_f32 v8, v8
    v_exp_f32 v9, v9
    v_exp_f32 v10, v10
    v_exp_f32 v11, v11
    v_pk_mul_f32 v[228:229], v[224:225], v[228:229]
    v_pk_mul_f32 v[230:231], v[226:227], v[230:231]
    v_pk_mul_f32 v[236:237], v[232:233], v[236:237]
    v_pk_mul_f32 v[238:239], v[234:235], v[238:239]
    v_pk_add_f32 v[4:5], v[4:5], 1.0 op_sel_hi:[1,0]
    v_pk_add_f32 v[6:7], v[6:7], 1.0 op_sel_hi:[1,0]
    v_pk_add_f32 v[8:9], v[8:9], 1.0 op_sel_hi:[1,0]
    v_pk_add_f32 v[10:11], v[10:11], 1.0 op_sel_hi:[1,0]
    v_rcp_f32 v4, v4
    v_rcp_f32 v5, v5
    v_rcp_f32 v6, v6
    v_rcp_f32 v7, v7
    v_rcp_f32 v8, v8
    v_rcp_f32 v9, v9
    v_rcp_f32 v10, v10
    v_rcp_f32 v11, v11
    s_nop 0
    v_pk_mul_f32 v[228:229], v[228:229], v[4:5]
    v_pk_mul_f32 v[230:231], v[230:231], v[6:7]
    v_pk_mul_f32 v[236:237], v[236:237], v[8:9]
    v_pk_mul_f32 v[238:239], v[238:239], v[10:11]
    v_cvt_pk_bf16_f32 v194, v228, v229
    v_cvt_pk_bf16_f32 v195, v230, v231
    s_mov_b64 exec, s[68:69]
    v_swap_b32 v192, v194
    v_swap_b32 v193, v195
    s_mov_b64 exec, -1
    buffer_store_dwordx4 v[192:195], v3, s[36:39], s64 offen offset:1024 sc1
    v_cvt_pk_bf16_f32 v202, v236, v237
    v_cvt_pk_bf16_f32 v203, v238, v239
    s_mov_b64 exec, s[68:69]
    v_swap_b32 v200, v202
    v_swap_b32 v201, v203
    s_mov_b64 exec, -1
    buffer_store_dwordx4 v[200:203], v3, s[36:39], s65 offen offset:1024 sc1
    v_pk_mul_f32 v[120:121], v[240:241], v[240:241]
    v_pk_mul_f32 v[122:123], v[242:243], v[242:243]
    v_pk_mul_f32 v[124:125], v[248:249], v[248:249]
    v_pk_mul_f32 v[126:127], v[250:251], v[250:251]
    v_pk_fma_f32 v[120:121], v[120:121], s[60:61], v[14:15]
    v_pk_fma_f32 v[122:123], v[122:123], s[60:61], v[14:15]
    v_pk_fma_f32 v[124:125], v[124:125], s[60:61], v[14:15]
    v_pk_fma_f32 v[126:127], v[126:127], s[60:61], v[14:15]
    v_pk_mul_f32 v[120:121], v[120:121], v[240:241]
    v_pk_mul_f32 v[122:123], v[122:123], v[242:243]
    v_pk_mul_f32 v[124:125], v[124:125], v[248:249]
    v_pk_mul_f32 v[126:127], v[126:127], v[250:251]
    v_exp_f32 v120, v120
    v_exp_f32 v121, v121
    v_exp_f32 v122, v122
    v_exp_f32 v123, v123
    v_exp_f32 v124, v124
    v_exp_f32 v125, v125
    v_exp_f32 v126, v126
    v_exp_f32 v127, v127
    v_pk_mul_f32 v[244:245], v[240:241], v[244:245]
    v_pk_mul_f32 v[246:247], v[242:243], v[246:247]
    v_pk_mul_f32 v[252:253], v[248:249], v[252:253]
    v_pk_mul_f32 v[254:255], v[250:251], v[254:255]
    v_pk_add_f32 v[120:121], v[120:121], 1.0 op_sel_hi:[1,0]
    v_pk_add_f32 v[122:123], v[122:123], 1.0 op_sel_hi:[1,0]
    v_pk_add_f32 v[124:125], v[124:125], 1.0 op_sel_hi:[1,0]
    v_pk_add_f32 v[126:127], v[126:127], 1.0 op_sel_hi:[1,0]
    v_rcp_f32 v120, v120
    v_rcp_f32 v121, v121
    v_rcp_f32 v122, v122
    v_rcp_f32 v123, v123
    v_rcp_f32 v124, v124
    v_rcp_f32 v125, v125
    v_rcp_f32 v126, v126
    v_rcp_f32 v127, v127
    s_nop 0
    v_pk_mul_f32 v[244:245], v[244:245], v[120:121]
    v_pk_mul_f32 v[246:247], v[246:247], v[122:123]
    v_pk_mul_f32 v[252:253], v[252:253], v[124:125]
    v_pk_mul_f32 v[254:255], v[254:255], v[126:127]
    v_cvt_pk_bf16_f32 v210, v244, v245
    v_cvt_pk_bf16_f32 v211, v246, v247
    s_mov_b64 exec, s[68:69]
    v_swap_b32 v208, v210
    v_swap_b32 v209, v211
    s_mov_b64 exec, -1
    buffer_store_dwordx4 v[208:211], v3, s[36:39], s66 offen offset:1024 sc1
    v_cvt_pk_bf16_f32 v218, v252, v253
    v_cvt_pk_bf16_f32 v219, v254, v255
    s_mov_b64 exec, s[68:69]
    v_swap_b32 v216, v218
    v_swap_b32 v217, v219
    s_mov_b64 exec, -1
    buffer_store_dwordx4 v[216:219], v3, s[36:39], s67 offen offset:1024 sc1
    s_and_b32 s60, s2, 7
    s_lshr_b32 s61, s2, 3
    s_lshr_b32 s62, s60, 1
    s_lshl_b32 s62, s62, 2
    s_lshr_b32 s63, s61, 3
    s_add_u32 s49, s62, s63
    s_and_b32 s50, s61, 7
    s_and_b32 s51, s60, 1
    s_mov_b32 s46, -1
    s_and_b32 s61, s50, 3
    s_cmp_eq_u32 s61, 1
    s_cbranch_scc1 L_f_skip
    s_max_u32 s61, s61, 1
    s_sub_u32 s61, s61, 1
    s_lshr_b32 s62, s2, 5
    s_mul_i32 s62, s62, 3
    s_add_u32 s61, s61, s62
    s_and_b32 s62, s2, 7
    s_lshl_b32 s60, s62, 4
    s_add_u32 s60, s60, s61
    s_lshl_b32 s60, s60, 2
    s_add_u32 s60, s60, s48
    s_cmp_lt_u32 s61, 16
    s_cbranch_scc1 L_f_has
    s_cmp_lg_u32 s60, 64
    s_cbranch_scc1 L_f_skip
    s_movk_i32 s60, 0x200
L_f_has:
    s_mov_b32 s46, s60
    s_waitcnt vmcnt(0)
    s_barrier
L_f_zchk:
    v_xor_b32 v8, s44, v116
    v_xor_b32 v9, s44, v117
    v_xor_b32 v10, s44, v118
    v_xor_b32 v11, s44, v119
    v_or3_b32 v8, v8, v9, v10
    v_or_b32 v8, v8, v11
    v_cmp_ne_u32 vcc, 0, v8
    s_cbranch_vccz L_f_zok
    s_sleep 8
    s_add_u32 s101, s101, 1
    s_cmp_gt_u32 s101, 0x100000
    s_cbranch_scc1 L_p1_end
    v_lshlrev_b32 v5, 4, v2
    s_mov_b32 s63, 0x01912000
    buffer_load_dwordx4 v[116:119], v5, s[36:39], s63 offen sc1
    s_waitcnt vmcnt(0)
    s_branch L_f_zchk
L_f_zok:
    s_mov_b32 s60, s46
    v_and_b32 v3, 31, v2
    v_lshrrev_b32 v4, 5, v2
    v_lshlrev_b32 v5, 2, v3
    v_add_u32 v5, v5, v4
    v_mul_u32_u24 v244, 16512, v5
    v_add_u32 v245, 33024, v244
    v_add_u32 v246, 2113536, v244
    v_add_u32 v247, 2146560, v244
    s_lshl_b32 s61, s60, 5
    s_add_u32 s61, s61, 0x01400000
    buffer_load_dwordx4 v[8:11], v244, s[36:39], s61 offen offset:0
    buffer_load_dwordx4 v[24:27], v244, s[36:39], s61 offen offset:16
    buffer_load_dwordx4 v[12:15], v245, s[36:39], s61 offen offset:0
    buffer_load_dwordx4 v[28:31], v245, s[36:39], s61 offen offset:16
    buffer_load_dwordx4 v[16:19], v246, s[36:39], s61 offen offset:0
    buffer_load_dwordx4 v[32:35], v246, s[36:39], s61 offen offset:16
    buffer_load_dwordx4 v[20:23], v247, s[36:39], s61 offen offset:0
    buffer_load_dwordx4 v[36:39], v247, s[36:39], s61 offen offset:16
    v_and_b32 v3, 31, v2
    v_lshrrev_b32 v4, 5, v2
    v_cvt_f32_u32 v210, v3
    v_cvt_f32_u32 v211, v4
    v_and_b32 v212, 1, v2
    v_mul_u32_u24 v212, 0x8000, v212
    v_mul_u32_u24 v212, 0x10001, v212
    v_mul_f32 v211, v210, v211
    v_mul_f32 v213, 0x3e000000, v211
    v_fmamk_f32 v214, v210, 0x00000000, v213
    v_fract_f32 v214, v214
    v_cos_f32 v64, v214
    v_sin_f32 v72, v214
    v_fmamk_f32 v215, v210, 0x3d000000, v213
    v_fract_f32 v215, v215
    v_cos_f32 v65, v215
    v_sin_f32 v73, v215
    v_fmamk_f32 v216, v210, 0x3d800000, v213
    v_fract_f32 v216, v216
    v_cos_f32 v66, v216
    v_sin_f32 v74, v216
    v_fmamk_f32 v217, v210, 0x3dc00000, v213
    v_fract_f32 v217, v217
    v_cos_f32 v67, v217
    v_sin_f32 v75, v217
    v_fmamk_f32 v214, v210, 0x3e800000, v213
    v_fract_f32 v214, v214
    v_cos_f32 v68, v214
    v_sin_f32 v76, v214
    v_fmamk_f32 v215, v210, 0x3e900000, v213
    v_fract_f32 v215, v215
    v_cos_f32 v69, v215
    v_sin_f32 v77, v215
    v_fmamk_f32 v216, v210, 0x3ea00000, v213
    v_fract_f32 v216, v216
    v_cos_f32 v70, v216
    v_sin_f32 v78, v216
    v_fmamk_f32 v217, v210, 0x3eb00000, v213
    v_fract_f32 v217, v217
    v_cos_f32 v71, v217
    v_sin_f32 v79, v217
    s_nop 0
    v_cvt_pk_bf16_f32 v40, v64, v65
    v_cvt_pk_bf16_f32 v48, v72, v73
    v_cvt_pk_bf16_f32 v41, v66, v67
    v_cvt_pk_bf16_f32 v49, v74, v75
    v_xor_b32 v42, v40, v212
    v_xor_b32 v50, v48, v212
    v_xor_b32 v43, v41, v212
    v_xor_b32 v51, v49, v212
    v_cvt_pk_bf16_f32 v44, v68, v69
    v_cvt_pk_bf16_f32 v52, v76, v77
    v_cvt_pk_bf16_f32 v45, v70, v71
    v_cvt_pk_bf16_f32 v53, v78, v79
    v_xor_b32 v46, v44, v212
    v_xor_b32 v54, v52, v212
    v_xor_b32 v47, v45, v212
    v_xor_b32 v55, v53, v212
    v_xor_b32 v56, 0x80008000, v48
    v_xor_b32 v57, 0x80008000, v49
    v_xor_b32 v58, 0x80008000, v50
    v_xor_b32 v59, 0x80008000, v51
    v_xor_b32 v60, 0x80008000, v52
    v_xor_b32 v61, 0x80008000, v53
    v_xor_b32 v62, 0x80008000, v54
    v_xor_b32 v63, 0x80008000, v55
    v_mul_f32 v213, 0x3d800000, v211
    v_fmamk_f32 v214, v210, 0x00000000, v213
    v_fract_f32 v214, v214
    v_cos_f32 v64, v214
    v_sin_f32 v72, v214
    v_fmamk_f32 v215, v210, 0x3c800000, v213
    v_fract_f32 v215, v215
    v_cos_f32 v65, v215
    v_sin_f32 v73, v215
    v_fmamk_f32 v216, v210, 0x3d000000, v213
    v_fract_f32 v216, v216
    v_cos_f32 v66, v216
    v_sin_f32 v74, v216
    v_fmamk_f32 v217, v210, 0x3d400000, v213
    v_fract_f32 v217, v217
    v_cos_f32 v67, v217
    v_sin_f32 v75, v217
    v_fmamk_f32 v214, v210, 0x3e000000, v213
    v_fract_f32 v214, v214
    v_cos_f32 v68, v214
    v_sin_f32 v76, v214
    v_fmamk_f32 v215, v210, 0x3e100000, v213
    v_fract_f32 v215, v215
    v_cos_f32 v69, v215
    v_sin_f32 v77, v215
    v_fmamk_f32 v216, v210, 0x3e200000, v213
    v_fract_f32 v216, v216
    v_cos_f32 v70, v216
    v_sin_f32 v78, v216
    v_fmamk_f32 v217, v210, 0x3e300000, v213
    v_fract_f32 v217, v217
    v_cos_f32 v71, v217
    v_sin_f32 v79, v217
    s_nop 0
    v_cvt_pk_bf16_f32 v192, v64, v65
    v_cvt_pk_bf16_f32 v200, v72, v73
    v_cvt_pk_bf16_f32 v193, v66, v67
    v_cvt_pk_bf16_f32 v201, v74, v75
    v_cvt_pk_bf16_f32 v194, v68, v69
    v_cvt_pk_bf16_f32 v202, v76, v77
    v_cvt_pk_bf16_f32 v195, v70, v71
    v_cvt_pk_bf16_f32 v203, v78, v79
    v_fmamk_f32 v214, v210, 0x3e800000, v213
    v_fract_f32 v214, v214
    v_cos_f32 v64, v214
    v_sin_f32 v72, v214
    v_fmamk_f32 v215, v210, 0x3e880000, v213
    v_fract_f32 v215, v215
    v_cos_f32 v65, v215
    v_sin_f32 v73, v215
    v_fmamk_f32 v216, v210, 0x3e900000, v213
    v_fract_f32 v216, v216
    v_cos_f32 v66, v216
    v_sin_f32 v74, v216
    v_fmamk_f32 v217, v210, 0x3e980000, v213
    v_fract_f32 v217, v217
    v_cos_f32 v67, v217
    v_sin_f32 v75, v217
    v_fmamk_f32 v214, v210, 0x3ec00000, v213
    v_fract_f32 v214, v214
    v_cos_f32 v68, v214
    v_sin_f32 v76, v214
    v_fmamk_f32 v215, v210, 0x3ec80000, v213
    v_fract_f32 v215, v215
    v_cos_f32 v69, v215
    v_sin_f32 v77, v215
    v_fmamk_f32 v216, v210, 0x3ed00000, v213
    v_fract_f32 v216, v216
    v_cos_f32 v70, v216
    v_sin_f32 v78, v216
    v_fmamk_f32 v217, v210, 0x3ed80000, v213
    v_fract_f32 v217, v217
    v_cos_f32 v71, v217
    v_sin_f32 v79, v217
    s_nop 0
    v_cvt_pk_bf16_f32 v196, v64, v65
    v_cvt_pk_bf16_f32 v204, v72, v73
    v_cvt_pk_bf16_f32 v197, v66, v67
    v_cvt_pk_bf16_f32 v205, v74, v75
    v_cvt_pk_bf16_f32 v198, v68, v69
    v_cvt_pk_bf16_f32 v206, v76, v77
    v_cvt_pk_bf16_f32 v199, v70, v71
    v_cvt_pk_bf16_f32 v207, v78, v79
    v_mul_f32 v213, 0x3b000000, v211
    v_fmamk_f32 v214, v210, 0x00000000, v213
    v_cos_f32 v128, v214
    v_sin_f32 v160, v214
    v_fmamk_f32 v215, v210, 0x3a000000, v213
    v_cos_f32 v129, v215
    v_sin_f32 v161, v215
    v_fmamk_f32 v216, v210, 0x3a800000, v213
    v_cos_f32 v130, v216
    v_sin_f32 v162, v216
    v_fmamk_f32 v217, v210, 0x3ac00000, v213
    v_cos_f32 v131, v217
    v_sin_f32 v163, v217
    v_fmamk_f32 v214, v210, 0x3b800000, v213
    v_cos_f32 v132, v214
    v_sin_f32 v164, v214
    v_fmamk_f32 v215, v210, 0x3b900000, v213
    v_cos_f32 v133, v215
    v_sin_f32 v165, v215
    v_fmamk_f32 v216, v210, 0x3ba00000, v213
    v_cos_f32 v134, v216
    v_sin_f32 v166, v216
    v_fmamk_f32 v217, v210, 0x3bb00000, v213
    v_cos_f32 v135, v217
    v_sin_f32 v167, v217
    v_fmamk_f32 v214, v210, 0x3c000000, v213
    v_cos_f32 v136, v214
    v_sin_f32 v168, v214
    v_fmamk_f32 v215, v210, 0x3c080000, v213
    v_cos_f32 v137, v215
    v_sin_f32 v169, v215
    v_fmamk_f32 v216, v210, 0x3c100000, v213
    v_cos_f32 v138, v216
    v_sin_f32 v170, v216
    v_fmamk_f32 v217, v210, 0x3c180000, v213
    v_cos_f32 v139, v217
    v_sin_f32 v171, v217
    v_fmamk_f32 v214, v210, 0x3c400000, v213
    v_cos_f32 v140, v214
    v_sin_f32 v172, v214
    v_fmamk_f32 v215, v210, 0x3c480000, v213
    v_cos_f32 v141, v215
    v_sin_f32 v173, v215
    v_fmamk_f32 v216, v210, 0x3c500000, v213
    v_cos_f32 v142, v216
    v_sin_f32 v174, v216
    v_fmamk_f32 v217, v210, 0x3c580000, v213
    v_cos_f32 v143, v217
    v_sin_f32 v175, v217
    v_fmamk_f32 v214, v210, 0x3c800000, v213
    v_cos_f32 v144, v214
    v_sin_f32 v176, v214
    v_fmamk_f32 v215, v210, 0x3c840000, v213
    v_cos_f32 v145, v215
    v_sin_f32 v177, v215
    v_fmamk_f32 v216, v210, 0x3c880000, v213
    v_cos_f32 v146, v216
    v_sin_f32 v178, v216
    v_fmamk_f32 v217, v210, 0x3c8c0000, v213
    v_cos_f32 v147, v217
    v_sin_f32 v179, v217
    v_fmamk_f32 v214, v210, 0x3ca00000, v213
    v_cos_f32 v148, v214
    v_sin_f32 v180, v214
    v_fmamk_f32 v215, v210, 0x3ca40000, v213
    v_cos_f32 v149, v215
    v_sin_f32 v181, v215
    v_fmamk_f32 v216, v210, 0x3ca80000, v213
    v_cos_f32 v150, v216
    v_sin_f32 v182, v216
    v_fmamk_f32 v217, v210, 0x3cac0000, v213
    v_cos_f32 v151, v217
    v_sin_f32 v183, v217
    v_fmamk_f32 v214, v210, 0x3cc00000, v213
    v_cos_f32 v152, v214
    v_sin_f32 v184, v214
    v_fmamk_f32 v215, v210, 0x3cc40000, v213
    v_cos_f32 v153, v215
    v_sin_f32 v185, v215
    v_fmamk_f32 v216, v210, 0x3cc80000, v213
    v_cos_f32 v154, v216
    v_sin_f32 v186, v216
    v_fmamk_f32 v217, v210, 0x3ccc0000, v213
    v_cos_f32 v155, v217
    v_sin_f32 v187, v217
    v_fmamk_f32 v214, v210, 0x3ce00000, v213
    v_cos_f32 v156, v214
    v_sin_f32 v188, v214
    v_fmamk_f32 v215, v210, 0x3ce40000, v213
    v_cos_f32 v157, v215
    v_sin_f32 v189, v215
    v_fmamk_f32 v216, v210, 0x3ce80000, v213
    v_cos_f32 v158, v216
    v_sin_f32 v190, v216
    v_fmamk_f32 v217, v210, 0x3cec0000, v213
    v_cos_f32 v159, v217
    v_sin_f32 v191, v217
L_f_chain:
    s_cmp_lg_u32 s60, 0
    s_cbranch_scc1 L_f_notag
    s_mov_b32 s61, 0x01910000
    v_mov_b32 v6, 0
    v_mov_b32 v7, s44
    s_mov_b64 exec, 1
    buffer_store_dword v7, v6, s[36:39], s61 offen sc1
    s_mov_b64 exec, -1
L_f_notag:
    s_waitcnt vmcnt(0)
    s_cmp_lg_u32 s60, 512
    s_cbranch_scc1 L_fft_nz
    v_mov_b32 v24, 0
    v_mov_b32 v25, 0
    v_mov_b32 v26, 0
    v_mov_b32 v27, 0
    v_mov_b32 v28, 0
    v_mov_b32 v29, 0
    v_mov_b32 v30, 0
    v_mov_b32 v31, 0
    v_mov_b32 v32, 0
    v_mov_b32 v33, 0
    v_mov_b32 v34, 0
    v_mov_b32 v35, 0
    v_mov_b32 v36, 0
    v_mov_b32 v37, 0
    v_mov_b32 v38, 0
    v_mov_b32 v39, 0
L_fft_nz:
    s_nop 1
    v_mfma_f32_32x32x16_bf16 v[64:79], v[8:11], v[40:43], 0
    v_mfma_f32_32x32x16_bf16 v[96:111], v[24:27], v[40:43], 0
    v_mfma_f32_32x32x16_bf16 v[64:79], v[24:27], v[48:51], v[64:79]
    v_mfma_f32_32x32x16_bf16 v[96:111], v[8:11], v[56:59], v[96:111]
    v_mfma_f32_32x32x16_bf16 v[80:95], v[16:19], v[40:43], 0
    v_mfma_f32_32x32x16_bf16 v[112:127], v[32:35], v[40:43], 0
    v_mfma_f32_32x32x16_bf16 v[80:95], v[32:35], v[48:51], v[80:95]
    v_mfma_f32_32x32x16_bf16 v[112:127], v[16:19], v[56:59], v[112:127]
    v_mfma_f32_32x32x16_bf16 v[64:79], v[12:15], v[44:47], v[64:79]
    v_mfma_f32_32x32x16_bf16 v[96:111], v[28:31], v[44:47], v[96:111]
    v_mfma_f32_32x32x16_bf16 v[64:79], v[28:31], v[52:55], v[64:79]
    v_mfma_f32_32x32x16_bf16 v[96:111], v[12:15], v[60:63], v[96:111]
    v_mfma_f32_32x32x16_bf16 v[80:95], v[20:23], v[44:47], v[80:95]
    v_mfma_f32_32x32x16_bf16 v[112:127], v[36:39], v[44:47], v[112:127]
    v_mfma_f32_32x32x16_bf16 v[80:95], v[36:39], v[52:55], v[80:95]
    v_mfma_f32_32x32x16_bf16 v[112:127], v[20:23], v[60:63], v[112:127]
    v_xor_b32 v220, v192, v212
    v_xor_b32 v221, v193, v212
    v_xor_b32 v222, v194, v212
    v_xor_b32 v223, v195, v212
    v_xor_b32 v224, v196, v212
    v_xor_b32 v225, v197, v212
    v_xor_b32 v226, v198, v212
    v_xor_b32 v227, v199, v212
    v_xor_b32 v228, v200, v212
    v_xor_b32 v229, v201, v212
    v_xor_b32 v230, v202, v212
    v_xor_b32 v231, v203, v212
    v_xor_b32 v232, v204, v212
    v_xor_b32 v233, v205, v212
    v_xor_b32 v234, v206, v212
    v_xor_b32 v235, v207, v212
    v_pk_mul_f32 v[236:237], v[64:65], v[128:129]
    v_pk_mul_f32 v[238:239], v[96:97], v[128:129]
    v_pk_fma_f32 v[236:237], v[96:97], v[160:161], v[236:237]
    v_pk_fma_f32 v[238:239], v[64:65], v[160:161], v[238:239] neg_lo:[1,0,0] neg_hi:[1,0,0]
    v_cvt_pk_bf16_f32 v8, v236, v237
    v_cvt_pk_bf16_f32 v24, v238, v239
    v_pk_mul_f32 v[240:241], v[66:67], v[130:131]
    v_pk_mul_f32 v[242:243], v[98:99], v[130:131]
    v_pk_fma_f32 v[240:241], v[98:99], v[162:163], v[240:241]
    v_pk_fma_f32 v[242:243], v[66:67], v[162:163], v[242:243] neg_lo:[1,0,0] neg_hi:[1,0,0]
    v_cvt_pk_bf16_f32 v9, v240, v241
    v_cvt_pk_bf16_f32 v25, v242, v243
    v_pk_mul_f32 v[236:237], v[68:69], v[132:133]
    v_pk_mul_f32 v[238:239], v[100:101], v[132:133]
    v_pk_fma_f32 v[236:237], v[100:101], v[164:165], v[236:237]
    v_pk_fma_f32 v[238:239], v[68:69], v[164:165], v[238:239] neg_lo:[1,0,0] neg_hi:[1,0,0]
    v_cvt_pk_bf16_f32 v10, v236, v237
    v_cvt_pk_bf16_f32 v26, v238, v239
    v_pk_mul_f32 v[240:241], v[70:71], v[134:135]
    v_pk_mul_f32 v[242:243], v[102:103], v[134:135]
    v_pk_fma_f32 v[240:241], v[102:103], v[166:167], v[240:241]
    v_pk_fma_f32 v[242:243], v[70:71], v[166:167], v[242:243] neg_lo:[1,0,0] neg_hi:[1,0,0]
    v_cvt_pk_bf16_f32 v11, v240, v241
    v_cvt_pk_bf16_f32 v27, v242, v243
    v_pk_mul_f32 v[236:237], v[72:73], v[136:137]
    v_pk_mul_f32 v[238:239], v[104:105], v[136:137]
    v_pk_fma_f32 v[236:237], v[104:105], v[168:169], v[236:237]
    v_pk_fma_f32 v[238:239], v[72:73], v[168:169], v[238:239] neg_lo:[1,0,0] neg_hi:[1,0,0]
    v_cvt_pk_bf16_f32 v12, v236, v237
    v_cvt_pk_bf16_f32 v28, v238, v239
    v_pk_mul_f32 v[240:241], v[74:75], v[138:139]
    v_pk_mul_f32 v[242:243], v[106:107], v[138:139]
    v_pk_fma_f32 v[240:241], v[106:107], v[170:171], v[240:241]
    v_pk_fma_f32 v[242:243], v[74:75], v[170:171], v[242:243] neg_lo:[1,0,0] neg_hi:[1,0,0]
    v_cvt_pk_bf16_f32 v13, v240, v241
    v_cvt_pk_bf16_f32 v29, v242, v243
    v_pk_mul_f32 v[236:237], v[76:77], v[140:141]
    v_pk_mul_f32 v[238:239], v[108:109], v[140:141]
    v_pk_fma_f32 v[236:237], v[108:109], v[172:173], v[236:237]
    v_pk_fma_f32 v[238:239], v[76:77], v[172:173], v[238:239] neg_lo:[1,0,0] neg_hi:[1,0,0]
    v_cvt_pk_bf16_f32 v14, v236, v237
    v_cvt_pk_bf16_f32 v30, v238, v239
    v_pk_mul_f32 v[240:241], v[78:79], v[142:143]
    v_pk_mul_f32 v[242:243], v[110:111], v[142:143]
    v_pk_fma_f32 v[240:241], v[110:111], v[174:175], v[240:241]
    v_pk_fma_f32 v[242:243], v[78:79], v[174:175], v[242:243] neg_lo:[1,0,0] neg_hi:[1,0,0]
    v_cvt_pk_bf16_f32 v15, v240, v241
    v_cvt_pk_bf16_f32 v31, v242, v243
    v_pk_mul_f32 v[236:237], v[80:81], v[144:145]
    v_pk_mul_f32 v[238:239], v[112:113], v[144:145]
    v_pk_fma_f32 v[236:237], v[112:113], v[176:177], v[236:237]
    v_pk_fma_f32 v[238:239], v[80:81], v[176:177], v[238:239] neg_lo:[1,0,0] neg_hi:[1,0,0]
    v_cvt_pk_bf16_f32 v16, v236, v237
    v_cvt_pk_bf16_f32 v32, v238, v239
    v_pk_mul_f32 v[240:241], v[82:83], v[146:147]
    v_pk_mul_f32 v[242:243], v[114:115], v[146:147]
    v_pk_fma_f32 v[240:241], v[114:115], v[178:179], v[240:241]
    v_pk_fma_f32 v[242:243], v[82:83], v[178:179], v[242:243] neg_lo:[1,0,0] neg_hi:[1,0,0]
    v_cvt_pk_bf16_f32 v17, v240, v241
    v_cvt_pk_bf16_f32 v33, v242, v243
    v_pk_mul_f32 v[236:237], v[84:85], v[148:149]
    v_pk_mul_f32 v[238:239], v[116:117], v[148:149]
    v_pk_fma_f32 v[236:237], v[116:117], v[180:181], v[236:237]
    v_pk_fma_f32 v[238:239], v[84:85], v[180:181], v[238:239] neg_lo:[1,0,0] neg_hi:[1,0,0]
    v_cvt_pk_bf16_f32 v18, v236, v237
    v_cvt_pk_bf16_f32 v34, v238, v239
    v_pk_mul_f32 v[240:241], v[86:87], v[150:151]
    v_pk_mul_f32 v[242:243], v[118:119], v[150:151]
    v_pk_fma_f32 v[240:241], v[118:119], v[182:183], v[240:241]
    v_pk_fma_f32 v[242:243], v[86:87], v[182:183], v[242:243] neg_lo:[1,0,0] neg_hi:[1,0,0]
    v_cvt_pk_bf16_f32 v19, v240, v241
    v_cvt_pk_bf16_f32 v35, v242, v243
    v_pk_mul_f32 v[236:237], v[88:89], v[152:153]
    v_pk_mul_f32 v[238:239], v[120:121], v[152:153]
    v_pk_fma_f32 v[236:237], v[120:121], v[184:185], v[236:237]
    v_pk_fma_f32 v[238:239], v[88:89], v[184:185], v[238:239] neg_lo:[1,0,0] neg_hi:[1,0,0]
    v_cvt_pk_bf16_f32 v20, v236, v237
    v_cvt_pk_bf16_f32 v36, v238, v239
    v_pk_mul_f32 v[240:241], v[90:91], v[154:155]
    v_pk_mul_f32 v[242:243], v[122:123], v[154:155]
    v_pk_fma_f32 v[240:241], v[122:123], v[186:187], v[240:241]
    v_pk_fma_f32 v[242:243], v[90:91], v[186:187], v[242:243] neg_lo:[1,0,0] neg_hi:[1,0,0]
    v_cvt_pk_bf16_f32 v21, v240, v241
    v_cvt_pk_bf16_f32 v37, v242, v243
    v_pk_mul_f32 v[236:237], v[92:93], v[156:157]
    v_pk_mul_f32 v[238:239], v[124:125], v[156:157]
    v_pk_fma_f32 v[236:237], v[124:125], v[188:189], v[236:237]
    v_pk_fma_f32 v[238:239], v[92:93], v[188:189], v[238:239] neg_lo:[1,0,0] neg_hi:[1,0,0]
    v_cvt_pk_bf16_f32 v22, v236, v237
    v_cvt_pk_bf16_f32 v38, v238, v239
    v_pk_mul_f32 v[240:241], v[94:95], v[158:159]
    v_pk_mul_f32 v[242:243], v[126:127], v[158:159]
    v_pk_fma_f32 v[240:241], v[126:127], v[190:191], v[240:241]
    v_pk_fma_f32 v[242:243], v[94:95], v[190:191], v[242:243] neg_lo:[1,0,0] neg_hi:[1,0,0]
    v_cvt_pk_bf16_f32 v23, v240, v241
    v_cvt_pk_bf16_f32 v39, v242, v243
    s_nop 1
    v_mfma_f32_32x32x16_bf16 v[64:79], v[192:195], v[8:11], 0
    v_xor_b32 v128, 0x80000000, v192
    v_xor_b32 v129, 0x80000000, v193
    v_xor_b32 v130, 0x80000000, v194
    v_xor_b32 v131, 0x80000000, v195
    v_mfma_f32_32x32x16_bf16 v[64:79], v[200:203], v[24:27], v[64:79]
    v_xor_b32 v132, 0x80000000, v200
    v_xor_b32 v133, 0x80000000, v201
    v_xor_b32 v134, 0x80000000, v202
    v_xor_b32 v135, 0x80000000, v203
    v_mfma_f32_32x32x16_bf16 v[64:79], v[196:199], v[12:15], v[64:79]
    v_xor_b32 v136, 0x80000000, v196
    v_xor_b32 v137, 0x80000000, v197
    v_xor_b32 v138, 0x80000000, v198
    v_xor_b32 v139, 0x80000000, v199
    v_mfma_f32_32x32x16_bf16 v[64:79], v[204:207], v[28:31], v[64:79]
    v_xor_b32 v140, 0x80000000, v204
    v_xor_b32 v141, 0x80000000, v205
    v_xor_b32 v142, 0x80000000, v206
    v_xor_b32 v143, 0x80000000, v207
    v_mfma_f32_32x32x16_bf16 v[64:79], v[220:223], v[16:19], v[64:79]
    v_xor_b32 v144, 0x80000000, v220
    v_xor_b32 v145, 0x80000000, v221
    v_xor_b32 v146, 0x80000000, v222
    v_xor_b32 v147, 0x80000000, v223
    v_mfma_f32_32x32x16_bf16 v[64:79], v[228:231], v[32:35], v[64:79]
    v_xor_b32 v148, 0x80000000, v228
    v_xor_b32 v149, 0x80000000, v229
    v_xor_b32 v150, 0x80000000, v230
    v_xor_b32 v151, 0x80000000, v231
    v_mfma_f32_32x32x16_bf16 v[64:79], v[224:227], v[20:23], v[64:79]
    v_xor_b32 v152, 0x80000000, v224
    v_xor_b32 v153, 0x80000000, v225
    v_xor_b32 v154, 0x80000000, v226
    v_xor_b32 v155, 0x80000000, v227
    v_mfma_f32_32x32x16_bf16 v[64:79], v[232:235], v[36:39], v[64:79]
    v_xor_b32 v156, 0x80000000, v232
    v_xor_b32 v157, 0x80000000, v233
    v_xor_b32 v158, 0x80000000, v234
    v_xor_b32 v159, 0x80000000, v235
    s_nop 1
    v_mfma_f32_32x32x16_bf16 v[80:95], v[128:131], v[8:11], 0
    v_mfma_f32_32x32x16_bf16 v[80:95], v[132:135], v[24:27], v[80:95]
    v_mfma_f32_32x32x16_bf16 v[80:95], v[136:139], v[12:15], v[80:95]
    v_mfma_f32_32x32x16_bf16 v[80:95], v[140:143], v[28:31], v[80:95]
    v_mfma_f32_32x32x16_bf16 v[80:95], v[144:147], v[16:19], v[80:95]
    v_mfma_f32_32x32x16_bf16 v[80:95], v[148:151], v[32:35], v[80:95]
    v_mfma_f32_32x32x16_bf16 v[80:95], v[152:155], v[20:23], v[80:95]
    v_mfma_f32_32x32x16_bf16 v[80:95], v[156:159], v[36:39], v[80:95]
    v_lshlrev_b32 v5, 2, v3
    v_lshlrev_b32 v6, 9, v4
    v_add_u32 v5, v5, v6
    s_lshl_b32 s61, s60, 13
    s_add_u32 s61, s61, 0x01a00000
    s_add_u32 s62, s61, 4096
    buffer_store_dword v64, v5, s[36:39], s61 offen offset:0 sc1
    buffer_store_dword v65, v5, s[36:39], s61 offen offset:128 sc1
    buffer_store_dword v66, v5, s[36:39], s61 offen offset:256 sc1
    buffer_store_dword v67, v5, s[36:39], s61 offen offset:384 sc1
    buffer_store_dword v68, v5, s[36:39], s61 offen offset:1024 sc1
    buffer_store_dword v69, v5, s[36:39], s61 offen offset:1152 sc1
    buffer_store_dword v70, v5, s[36:39], s61 offen offset:1280 sc1
    buffer_store_dword v71, v5, s[36:39], s61 offen offset:1408 sc1
    buffer_store_dword v72, v5, s[36:39], s61 offen offset:2048 sc1
    buffer_store_dword v73, v5, s[36:39], s61 offen offset:2176 sc1
    buffer_store_dword v74, v5, s[36:39], s61 offen offset:2304 sc1
    buffer_store_dword v75, v5, s[36:39], s61 offen offset:2432 sc1
    buffer_store_dword v76, v5, s[36:39], s61 offen offset:3072 sc1
    buffer_store_dword v77, v5, s[36:39], s61 offen offset:3200 sc1
    buffer_store_dword v78, v5, s[36:39], s61 offen offset:3328 sc1
    buffer_store_dword v79, v5, s[36:39], s61 offen offset:3456 sc1
    s_nop 7
    buffer_store_dword v80, v5, s[36:39], s62 offen offset:0 sc1
    buffer_store_dword v81, v5, s[36:39], s62 offen offset:128 sc1
    buffer_store_dword v82, v5, s[36:39], s62 offen offset:256 sc1
    buffer_store_dword v83, v5, s[36:39], s62 offen offset:384 sc1
    buffer_store_dword v84, v5, s[36:39], s62 offen offset:1024 sc1
    buffer_store_dword v85, v5, s[36:39], s62 offen offset:1152 sc1
    buffer_store_dword v86, v5, s[36:39], s62 offen offset:1280 sc1
    buffer_store_dword v87, v5, s[36:39], s62 offen offset:1408 sc1
    buffer_store_dword v88, v5, s[36:39], s62 offen offset:2048 sc1
    buffer_store_dword v89, v5, s[36:39], s62 offen offset:2176 sc1
    buffer_store_dword v90, v5, s[36:39], s62 offen offset:2304 sc1
    buffer_store_dword v91, v5, s[36:39], s62 offen offset:2432 sc1
    buffer_store_dword v92, v5, s[36:39], s62 offen offset:3072 sc1
    buffer_store_dword v93, v5, s[36:39], s62 offen offset:3200 sc1
    buffer_store_dword v94, v5, s[36:39], s62 offen offset:3328 sc1
    buffer_store_dword v95, v5, s[36:39], s62 offen offset:3456 sc1
    s_branch L_f_go
L_f_skip:
    s_waitcnt vmcnt(0)
    s_barrier
L_f_go:
    s_and_b32 s60, s48, 1
    s_lshl_b32 s60, s60, 11
    v_lshlrev_b32 v3, 4, v2
    v_add_u32 v121, s60, v3
    v_and_b32 v3, 16, v2
    v_lshrrev_b32 v3, 1, v3
    v_add_u32 v121, v121, v3
    s_lshr_b32 s61, s48, 1
    s_lshl_b32 s61, s61, 2
    v_lshrrev_b32 v4, 2, v2
    v_and_b32 v5, 7, v4
    v_xor_b32 v5, s61, v5
    v_lshlrev_b32 v4, 8, v4
    v_and_b32 v6, 3, v2
    v_lshlrev_b32 v6, 3, v6
    v_add_u32 v4, v4, v6
    v_add_u32 v4, 0x4000, v4
    v_lshlrev_b32 v5, 5, v5
    v_add_u32 v122, v4, v5
    v_xor_b32 v123, 32, v122
    v_xor_b32 v124, 64, v122
    v_xor_b32 v125, 96, v122
    v_add_u32 v116, 98304, v121
    v_xor_b32 v115, 8, v116
    v_add_u32 v117, 98304, v122
    v_add_u32 v118, 98304, v123
    v_add_u32 v119, 98304, v124
    v_add_u32 v120, 98304, v125
    s_mov_b32 s52, 0
    s_mov_b32 s96, 98304
    s_barrier
    ds_read_b64_tr_b16 v[144:145], v117 offset:0
    ds_read_b64_tr_b16 v[146:147], v117 offset:4096
    ds_read_b64 v[128:129], v116 offset:0
    ds_read_b64 v[130:131], v116 offset:4096
    ds_read_b64_tr_b16 v[148:149], v118 offset:0
    ds_read_b64_tr_b16 v[150:151], v118 offset:4096
    ds_read_b64 v[132:133], v115 offset:0
    ds_read_b64 v[134:135], v115 offset:4096
    ds_read_b64_tr_b16 v[152:153], v119 offset:0
    ds_read_b64_tr_b16 v[154:155], v119 offset:4096
    ds_read_b64 v[136:137], v116 offset:1024
    ds_read_b64 v[138:139], v116 offset:5120
    ds_read_b64_tr_b16 v[156:157], v120 offset:0
    ds_read_b64_tr_b16 v[158:159], v120 offset:4096
    ds_read_b64 v[140:141], v115 offset:1024
    ds_read_b64 v[142:143], v115 offset:5120
    s_waitcnt lgkmcnt(8)
    v_mfma_f32_16x16x32_bf16 v[192:195], v[144:147], v[128:131], 0
    ds_read_b64_tr_b16 v[176:177], v117 offset:8192
    ds_read_b64_tr_b16 v[178:179], v117 offset:12288
    v_mfma_f32_16x16x32_bf16 v[196:199], v[148:151], v[128:131], 0
    ds_read_b64 v[160:161], v116 offset:8192
    ds_read_b64 v[162:163], v116 offset:12288
    v_mfma_f32_16x16x32_bf16 v[212:215], v[148:151], v[132:135], 0
    s_waitcnt lgkmcnt(8)
    ds_read_b64_tr_b16 v[180:181], v118 offset:8192
    ds_read_b64_tr_b16 v[182:183], v118 offset:12288
    v_mfma_f32_16x16x32_bf16 v[208:211], v[144:147], v[132:135], 0
    ds_read_b64 v[164:165], v115 offset:8192
    ds_read_b64 v[166:167], v115 offset:12288
    v_mfma_f32_16x16x32_bf16 v[224:227], v[144:147], v[136:139], 0
    s_waitcnt lgkmcnt(8)
    ds_read_b64_tr_b16 v[184:185], v119 offset:8192
    ds_read_b64_tr_b16 v[186:187], v119 offset:12288
    v_mfma_f32_16x16x32_bf16 v[228:231], v[148:151], v[136:139], 0
    ds_read_b64 v[168:169], v116 offset:9216
    ds_read_b64 v[170:171], v116 offset:13312
    v_mfma_f32_16x16x32_bf16 v[232:235], v[152:155], v[136:139], 0
    ds_read_b64_tr_b16 v[188:189], v120 offset:8192
    ds_read_b64_tr_b16 v[190:191], v120 offset:12288
    v_mfma_f32_16x16x32_bf16 v[216:219], v[152:155], v[132:135], 0
    ds_read_b64 v[172:173], v115 offset:9216
    ds_read_b64 v[174:175], v115 offset:13312
    v_mfma_f32_16x16x32_bf16 v[200:203], v[152:155], v[128:131], 0
    v_mfma_f32_16x16x32_bf16 v[204:207], v[156:159], v[128:131], 0
    s_add_u32 s96, s96, 32768
    s_cmp_ge_u32 s96, 163840
    v_mfma_f32_16x16x32_bf16 v[220:223], v[156:159], v[132:135], 0
    s_cselect_b32 s96, 0, s96
    v_mfma_f32_16x16x32_bf16 v[236:239], v[156:159], v[136:139], 0
    v_add_u32 v116, s96, v121
    v_mfma_f32_16x16x32_bf16 v[252:255], v[156:159], v[140:143], 0
    v_add_u32 v117, s96, v122
    v_xor_b32 v115, 8, v116
    v_mfma_f32_16x16x32_bf16 v[248:251], v[152:155], v[140:143], 0
    v_add_u32 v118, s96, v123
    v_mfma_f32_16x16x32_bf16 v[244:247], v[148:151], v[140:143], 0
    v_add_u32 v119, s96, v124
    v_mfma_f32_16x16x32_bf16 v[240:243], v[144:147], v[140:143], 0
    v_add_u32 v120, s96, v125
    s_branch L_p2_cmid
    .p2align 6
L_p2_cloop:
    s_waitcnt lgkmcnt(8)
    v_mfma_f32_16x16x32_bf16 v[192:195], v[144:147], v[128:131], v[192:195]
    ds_read_b64_tr_b16 v[176:177], v117 offset:8192
    ds_read_b64_tr_b16 v[178:179], v117 offset:12288
    v_mfma_f32_16x16x32_bf16 v[196:199], v[148:151], v[128:131], v[196:199]
    ds_read_b64 v[160:161], v116 offset:8192
    ds_read_b64 v[162:163], v116 offset:12288
    v_mfma_f32_16x16x32_bf16 v[212:215], v[148:151], v[132:135], v[212:215]
    s_waitcnt lgkmcnt(8)
    ds_read_b64_tr_b16 v[180:181], v118 offset:8192
    ds_read_b64_tr_b16 v[182:183], v118 offset:12288
    v_mfma_f32_16x16x32_bf16 v[208:211], v[144:147], v[132:135], v[208:211]
    ds_read_b64 v[164:165], v115 offset:8192
    ds_read_b64 v[166:167], v115 offset:12288
    v_mfma_f32_16x16x32_bf16 v[224:227], v[144:147], v[136:139], v[224:227]
    s_waitcnt lgkmcnt(8)
    ds_read_b64_tr_b16 v[184:185], v119 offset:8192
    ds_read_b64_tr_b16 v[186:187], v119 offset:12288
    v_mfma_f32_16x16x32_bf16 v[228:231], v[148:151], v[136:139], v[228:231]
    ds_read_b64 v[168:169], v116 offset:9216
    ds_read_b64 v[170:171], v116 offset:13312
    v_mfma_f32_16x16x32_bf16 v[232:235], v[152:155], v[136:139], v[232:235]
    ds_read_b64_tr_b16 v[188:189], v120 offset:8192
    ds_read_b64_tr_b16 v[190:191], v120 offset:12288
    v_mfma_f32_16x16x32_bf16 v[216:219], v[152:155], v[132:135], v[216:219]
    ds_read_b64 v[172:173], v115 offset:9216
    ds_read_b64 v[174:175], v115 offset:13312
    v_mfma_f32_16x16x32_bf16 v[200:203], v[152:155], v[128:131], v[200:203]
    v_mfma_f32_16x16x32_bf16 v[204:207], v[156:159], v[128:131], v[204:207]
    s_add_u32 s96, s96, 32768
    s_cmp_ge_u32 s96, 163840
    v_mfma_f32_16x16x32_bf16 v[220:223], v[156:159], v[132:135], v[220:223]
    s_cselect_b32 s96, 0, s96
    v_mfma_f32_16x16x32_bf16 v[236:239], v[156:159], v[136:139], v[236:239]
    v_add_u32 v116, s96, v121
    v_mfma_f32_16x16x32_bf16 v[252:255], v[156:159], v[140:143], v[252:255]
    v_add_u32 v117, s96, v122
    v_xor_b32 v115, 8, v116
    v_mfma_f32_16x16x32_bf16 v[248:251], v[152:155], v[140:143], v[248:251]
    v_add_u32 v118, s96, v123
    v_mfma_f32_16x16x32_bf16 v[244:247], v[148:151], v[140:143], v[244:247]
    v_add_u32 v119, s96, v124
    v_mfma_f32_16x16x32_bf16 v[240:243], v[144:147], v[140:143], v[240:243]
    v_add_u32 v120, s96, v125
L_p2_cmid:
    s_waitcnt lgkmcnt(0)
    s_barrier
    v_mfma_f32_16x16x32_bf16 v[192:195], v[176:179], v[160:163], v[192:195]
    ds_read_b64_tr_b16 v[144:145], v117 offset:0
    v_mfma_f32_16x16x32_bf16 v[196:199], v[180:183], v[160:163], v[196:199]
    ds_read_b64_tr_b16 v[146:147], v117 offset:4096
    v_mfma_f32_16x16x32_bf16 v[212:215], v[180:183], v[164:167], v[212:215]
    ds_read_b64 v[128:129], v116 offset:0
    v_mfma_f32_16x16x32_bf16 v[208:211], v[176:179], v[164:167], v[208:211]
    ds_read_b64 v[130:131], v116 offset:4096
    v_mfma_f32_16x16x32_bf16 v[224:227], v[176:179], v[168:171], v[224:227]
    ds_read_b64_tr_b16 v[148:149], v118 offset:0
    v_mfma_f32_16x16x32_bf16 v[228:231], v[180:183], v[168:171], v[228:231]
    ds_read_b64_tr_b16 v[150:151], v118 offset:4096
    v_mfma_f32_16x16x32_bf16 v[232:235], v[184:187], v[168:171], v[232:235]
    ds_read_b64 v[132:133], v115 offset:0
    v_mfma_f32_16x16x32_bf16 v[216:219], v[184:187], v[164:167], v[216:219]
    ds_read_b64 v[134:135], v115 offset:4096
    v_mfma_f32_16x16x32_bf16 v[200:203], v[184:187], v[160:163], v[200:203]
    ds_read_b64_tr_b16 v[152:153], v119 offset:0
    v_mfma_f32_16x16x32_bf16 v[204:207], v[188:191], v[160:163], v[204:207]
    ds_read_b64_tr_b16 v[154:155], v119 offset:4096
    v_mfma_f32_16x16x32_bf16 v[220:223], v[188:191], v[164:167], v[220:223]
    ds_read_b64 v[136:137], v116 offset:1024
    v_mfma_f32_16x16x32_bf16 v[236:239], v[188:191], v[168:171], v[236:239]
    ds_read_b64 v[138:139], v116 offset:5120
    v_mfma_f32_16x16x32_bf16 v[252:255], v[188:191], v[172:175], v[252:255]
    ds_read_b64_tr_b16 v[156:157], v120 offset:0
    s_cmp_eq_u32 s52, 3
    s_cbranch_scc1 L_p2_drain
L_p2_draind:
    v_mfma_f32_16x16x32_bf16 v[248:251], v[184:187], v[172:175], v[248:251]
    ds_read_b64_tr_b16 v[158:159], v120 offset:4096
    v_mfma_f32_16x16x32_bf16 v[244:247], v[180:183], v[172:175], v[244:247]
    ds_read_b64 v[140:141], v115 offset:1024
    v_mfma_f32_16x16x32_bf16 v[240:243], v[176:179], v[172:175], v[240:243]
    ds_read_b64 v[142:143], v115 offset:5120
    s_waitcnt lgkmcnt(8)
    v_mfma_f32_16x16x32_bf16 v[192:195], v[144:147], v[128:131], v[192:195]
    ds_read_b64_tr_b16 v[176:177], v117 offset:8192
    ds_read_b64_tr_b16 v[178:179], v117 offset:12288
    v_mfma_f32_16x16x32_bf16 v[196:199], v[148:151], v[128:131], v[196:199]
    ds_read_b64 v[160:161], v116 offset:8192
    ds_read_b64 v[162:163], v116 offset:12288
    v_mfma_f32_16x16x32_bf16 v[212:215], v[148:151], v[132:135], v[212:215]
    s_waitcnt lgkmcnt(8)
    ds_read_b64_tr_b16 v[180:181], v118 offset:8192
    ds_read_b64_tr_b16 v[182:183], v118 offset:12288
    v_mfma_f32_16x16x32_bf16 v[208:211], v[144:147], v[132:135], v[208:211]
    ds_read_b64 v[164:165], v115 offset:8192
    ds_read_b64 v[166:167], v115 offset:12288
    v_mfma_f32_16x16x32_bf16 v[224:227], v[144:147], v[136:139], v[224:227]
    s_waitcnt lgkmcnt(8)
    ds_read_b64_tr_b16 v[184:185], v119 offset:8192
    ds_read_b64_tr_b16 v[186:187], v119 offset:12288
    v_mfma_f32_16x16x32_bf16 v[228:231], v[148:151], v[136:139], v[228:231]
    ds_read_b64 v[168:169], v116 offset:9216
    ds_read_b64 v[170:171], v116 offset:13312
    v_mfma_f32_16x16x32_bf16 v[232:235], v[152:155], v[136:139], v[232:235]
    ds_read_b64_tr_b16 v[188:189], v120 offset:8192
    ds_read_b64_tr_b16 v[190:191], v120 offset:12288
    v_mfma_f32_16x16x32_bf16 v[216:219], v[152:155], v[132:135], v[216:219]
    ds_read_b64 v[172:173], v115 offset:9216
    ds_read_b64 v[174:175], v115 offset:13312
    v_mfma_f32_16x16x32_bf16 v[200:203], v[152:155], v[128:131], v[200:203]
    v_mfma_f32_16x16x32_bf16 v[204:207], v[156:159], v[128:131], v[204:207]
    s_add_u32 s96, s96, 32768
    s_cmp_ge_u32 s96, 163840
    v_mfma_f32_16x16x32_bf16 v[220:223], v[156:159], v[132:135], v[220:223]
    s_cselect_b32 s96, 0, s96
    v_mfma_f32_16x16x32_bf16 v[236:239], v[156:159], v[136:139], v[236:239]
    v_add_u32 v116, s96, v121
    v_mfma_f32_16x16x32_bf16 v[252:255], v[156:159], v[140:143], v[252:255]
    v_add_u32 v117, s96, v122
    v_xor_b32 v115, 8, v116
    v_mfma_f32_16x16x32_bf16 v[248:251], v[152:155], v[140:143], v[248:251]
    v_add_u32 v118, s96, v123
    v_mfma_f32_16x16x32_bf16 v[244:247], v[148:151], v[140:143], v[244:247]
    v_add_u32 v119, s96, v124
    v_mfma_f32_16x16x32_bf16 v[240:243], v[144:147], v[140:143], v[240:243]
    v_add_u32 v120, s96, v125
    s_cmp_eq_u32 s52, 13
    s_waitcnt lgkmcnt(0)
    s_cbranch_scc1 L_p2_nobar
    s_barrier
L_p2_nobar:
    v_mfma_f32_16x16x32_bf16 v[192:195], v[176:179], v[160:163], v[192:195]
    ds_read_b64_tr_b16 v[144:145], v117 offset:0
    v_mfma_f32_16x16x32_bf16 v[196:199], v[180:183], v[160:163], v[196:199]
    ds_read_b64_tr_b16 v[146:147], v117 offset:4096
    v_mfma_f32_16x16x32_bf16 v[212:215], v[180:183], v[164:167], v[212:215]
    ds_read_b64 v[128:129], v116 offset:0
    v_mfma_f32_16x16x32_bf16 v[208:211], v[176:179], v[164:167], v[208:211]
    ds_read_b64 v[130:131], v116 offset:4096
    v_mfma_f32_16x16x32_bf16 v[224:227], v[176:179], v[168:171], v[224:227]
    ds_read_b64_tr_b16 v[148:149], v118 offset:0
    v_mfma_f32_16x16x32_bf16 v[228:231], v[180:183], v[168:171], v[228:231]
    ds_read_b64_tr_b16 v[150:151], v118 offset:4096
    v_mfma_f32_16x16x32_bf16 v[232:235], v[184:187], v[168:171], v[232:235]
    ds_read_b64 v[132:133], v115 offset:0
    v_mfma_f32_16x16x32_bf16 v[216:219], v[184:187], v[164:167], v[216:219]
    ds_read_b64 v[134:135], v115 offset:4096
    v_mfma_f32_16x16x32_bf16 v[200:203], v[184:187], v[160:163], v[200:203]
    ds_read_b64_tr_b16 v[152:153], v119 offset:0
    v_mfma_f32_16x16x32_bf16 v[204:207], v[188:191], v[160:163], v[204:207]
    ds_read_b64_tr_b16 v[154:155], v119 offset:4096
    v_mfma_f32_16x16x32_bf16 v[220:223], v[188:191], v[164:167], v[220:223]
    ds_read_b64 v[136:137], v116 offset:1024
    v_mfma_f32_16x16x32_bf16 v[236:239], v[188:191], v[168:171], v[236:239]
    ds_read_b64 v[138:139], v116 offset:5120
    v_mfma_f32_16x16x32_bf16 v[252:255], v[188:191], v[172:175], v[252:255]
    ds_read_b64_tr_b16 v[156:157], v120 offset:0
    v_mfma_f32_16x16x32_bf16 v[248:251], v[184:187], v[172:175], v[248:251]
    ds_read_b64_tr_b16 v[158:159], v120 offset:4096
    v_mfma_f32_16x16x32_bf16 v[244:247], v[180:183], v[172:175], v[244:247]
    ds_read_b64 v[140:141], v115 offset:1024
    v_mfma_f32_16x16x32_bf16 v[240:243], v[176:179], v[172:175], v[240:243]
    ds_read_b64 v[142:143], v115 offset:5120
    s_add_u32 s52, s52, 1
    s_cmp_lt_u32 s52, 14
    s_cbranch_scc1 L_p2_cloop
L_c_tail:
    s_waitcnt lgkmcnt(0)
    s_nop 7
    s_lshr_b32 s60, s48, 1
    s_and_b32 s61, s48, 1
    s_lshl_b32 s61, s61, 14
    v_lshlrev_b32 v3, 4, v2
    s_cmp_eq_u32 s60, s51
    s_cbranch_scc1 L_p2_own
    s_xor_b32 s62, s2, 1
    s_mul_i32 s62, s62, 32768
    s_add_u32 s62, s62, s61
    s_add_u32 s62, s62, 0x01f00000
    s_movk_i32 s63, 0xfff
    v_mov_b32 v5, s44
    v_bfi_b32 v192, s63, v5, v192
    v_bfi_b32 v193, s63, v5, v193
    v_bfi_b32 v194, s63, v5, v194
    v_bfi_b32 v195, s63, v5, v195
    buffer_store_dwordx4 v[192:195], v3, s[36:39], s62 offen offset:0 sc1
    v_bfi_b32 v196, s63, v5, v196
    v_bfi_b32 v197, s63, v5, v197
    v_bfi_b32 v198, s63, v5, v198
    v_bfi_b32 v199, s63, v5, v199
    buffer_store_dwordx4 v[196:199], v3, s[36:39], s62 offen offset:1024 sc1
    v_bfi_b32 v200, s63, v5, v200
    v_bfi_b32 v201, s63, v5, v201
    v_bfi_b32 v202, s63, v5, v202
    v_bfi_b32 v203, s63, v5, v203
    buffer_store_dwordx4 v[200:203], v3, s[36:39], s62 offen offset:2048 sc1
    v_bfi_b32 v204, s63, v5, v204
    v_bfi_b32 v205, s63, v5, v205
    v_bfi_b32 v206, s63, v5, v206
    v_bfi_b32 v207, s63, v5, v207
    buffer_store_dwordx4 v[204:207], v3, s[36:39], s62 offen offset:3072 sc1
    s_add_u32 s62, s62, 4096
    v_bfi_b32 v208, s63, v5, v208
    v_bfi_b32 v209, s63, v5, v209
    v_bfi_b32 v210, s63, v5, v210
    v_bfi_b32 v211, s63, v5, v211
    buffer_store_dwordx4 v[208:211], v3, s[36:39], s62 offen offset:0 sc1
    v_bfi_b32 v212, s63, v5, v212
    v_bfi_b32 v213, s63, v5, v213
    v_bfi_b32 v214, s63, v5, v214
    v_bfi_b32 v215, s63, v5, v215
    buffer_store_dwordx4 v[212:215], v3, s[36:39], s62 offen offset:1024 sc1
    v_bfi_b32 v216, s63, v5, v216
    v_bfi_b32 v217, s63, v5, v217
    v_bfi_b32 v218, s63, v5, v218
    v_bfi_b32 v219, s63, v5, v219
    buffer_store_dwordx4 v[216:219], v3, s[36:39], s62 offen offset:2048 sc1
    v_bfi_b32 v220, s63, v5, v220
    v_bfi_b32 v221, s63, v5, v221
    v_bfi_b32 v222, s63, v5, v222
    v_bfi_b32 v223, s63, v5, v223
    buffer_store_dwordx4 v[220:223], v3, s[36:39], s62 offen offset:3072 sc1
    s_add_u32 s62, s62, 4096
    v_bfi_b32 v224, s63, v5, v224
    v_bfi_b32 v225, s63, v5, v225
    v_bfi_b32 v226, s63, v5, v226
    v_bfi_b32 v227, s63, v5, v227
    buffer_store_dwordx4 v[224:227], v3, s[36:39], s62 offen offset:0 sc1
    v_bfi_b32 v228, s63, v5, v228
    v_bfi_b32 v229, s63, v5, v229
    v_bfi_b32 v230, s63, v5, v230
    v_bfi_b32 v231, s63, v5, v231
    buffer_store_dwordx4 v[228:231], v3, s[36:39], s62 offen offset:1024 sc1
    v_bfi_b32 v232, s63, v5, v232
    v_bfi_b32 v233, s63, v5, v233
    v_bfi_b32 v234, s63, v5, v234
    v_bfi_b32 v235, s63, v5, v235
    buffer_store_dwordx4 v[232:235], v3, s[36:39], s62 offen offset:2048 sc1
    v_bfi_b32 v236, s63, v5, v236
    v_bfi_b32 v237, s63, v5, v237
    v_bfi_b32 v238, s63, v5, v238
    v_bfi_b32 v239, s63, v5, v239
    buffer_store_dwordx4 v[236:239], v3, s[36:39], s62 offen offset:3072 sc1
    s_add_u32 s62, s62, 4096
    v_bfi_b32 v240, s63, v5, v240
    v_bfi_b32 v241, s63, v5, v241
    v_bfi_b32 v242, s63, v5, v242
    v_bfi_b32 v243, s63, v5, v243
    buffer_store_dwordx4 v[240:243], v3, s[36:39], s62 offen offset:0 sc1
    v_bfi_b32 v244, s63, v5, v244
    v_bfi_b32 v245, s63, v5, v245
    v_bfi_b32 v246, s63, v5, v246
    v_bfi_b32 v247, s63, v5, v247
    buffer_store_dwordx4 v[244:247], v3, s[36:39], s62 offen offset:1024 sc1
    v_bfi_b32 v248, s63, v5, v248
    v_bfi_b32 v249, s63, v5, v249
    v_bfi_b32 v250, s63, v5, v250
    v_bfi_b32 v251, s63, v5, v251
    buffer_store_dwordx4 v[248:251], v3, s[36:39], s62 offen offset:2048 sc1
    v_bfi_b32 v252, s63, v5, v252
    v_bfi_b32 v253, s63, v5, v253
    v_bfi_b32 v254, s63, v5, v254
    v_bfi_b32 v255, s63, v5, v255
    buffer_store_dwordx4 v[252:255], v3, s[36:39], s62 offen offset:3072 sc1
    s_add_u32 s62, s62, 4096
    s_barrier
    s_branch L_p2_cend
L_p2_own:
    v_add_u32 v3, s61, v3
    ds_write_b128 v3, v[192:195] offset:32768
    ds_write_b128 v3, v[196:199] offset:33792
    ds_write_b128 v3, v[200:203] offset:34816
    ds_write_b128 v3, v[204:207] offset:35840
    ds_write_b128 v3, v[208:211] offset:36864
    ds_write_b128 v3, v[212:215] offset:37888
    ds_write_b128 v3, v[216:219] offset:38912
    ds_write_b128 v3, v[220:223] offset:39936
    ds_write_b128 v3, v[224:227] offset:40960
    ds_write_b128 v3, v[228:231] offset:41984
    ds_write_b128 v3, v[232:235] offset:43008
    ds_write_b128 v3, v[236:239] offset:44032
    ds_write_b128 v3, v[240:243] offset:45056
    ds_write_b128 v3, v[244:247] offset:46080
    ds_write_b128 v3, v[248:251] offset:47104
    ds_write_b128 v3, v[252:255] offset:48128
    s_waitcnt lgkmcnt(0)
    s_barrier
L_p2_cend:
    s_endpgm
L_p2_drain:
    s_cmp_eq_u32 s46, -1
    s_cbranch_scc1 L_p2_draind
    s_lshl_b32 s60, s46, 2
    s_add_u32 s60, s60, 0x01914000
    v_mov_b32 v3, 0
    v_mov_b32 v4, s44
    s_waitcnt vmcnt(0)
    s_mov_b64 exec, 1
    buffer_store_dword v4, v3, s[36:39], s60 offen sc1
    s_mov_b64 exec, -1
    s_branch L_p2_draind
L_p1_g1:
    ds_read_b128 v[16:19], v112 offset:0
    ds_read_b64_tr_b16 v[32:33], v114 offset:0
    ds_read_b64_tr_b16 v[34:35], v114 offset:1024
    ds_read_b64_tr_b16 v[36:37], v114 offset:2048
    ds_read_b64_tr_b16 v[38:39], v114 offset:3072
    ds_read_b64_tr_b16 v[40:41], v115 offset:0
    ds_read_b64_tr_b16 v[42:43], v115 offset:1024
    ds_read_b64_tr_b16 v[44:45], v115 offset:2048
    ds_read_b64_tr_b16 v[46:47], v115 offset:3072
    ds_read_b64_tr_b16 v[48:49], v116 offset:0
    ds_read_b64_tr_b16 v[50:51], v116 offset:1024
    ds_read_b64_tr_b16 v[52:53], v116 offset:2048
    ds_read_b64_tr_b16 v[54:55], v116 offset:3072
    ds_read_b128 v[20:23], v112 offset:2048
    ds_read_b128 v[24:27], v112 offset:4096
    ds_read_b128 v[28:31], v112 offset:6144
    s_waitcnt lgkmcnt(0)
    s_barrier
    s_setprio 1
    s_waitcnt lgkmcnt(0)
    v_mfma_f32_16x16x32_bf16 v[128:131], v[32:35], v[16:19], 0
    ds_read_b128 v[64:67], v113 offset:0
    v_add_f32_dpp v14, v14, v14 quad_perm:[1,0,3,2] row_mask:0xf bank_mask:0xf
    v_add_f32_dpp v15, v15, v15 quad_perm:[1,0,3,2] row_mask:0xf bank_mask:0xf
    v_mfma_f32_16x16x32_bf16 v[160:163], v[32:35], v[20:23], 0
    ds_read_b64_tr_b16 v[80:81], v114 offset:16384
    s_add_u32 m0, s57, s59
    v_add_f32_dpp v14, v14, v14 quad_perm:[2,3,0,1] row_mask:0xf bank_mask:0xf
    v_add_f32_dpp v15, v15, v15 quad_perm:[2,3,0,1] row_mask:0xf bank_mask:0xf
    v_mfma_f32_16x16x32_bf16 v[192:195], v[32:35], v[24:27], 0
    ds_read_b64_tr_b16 v[82:83], v114 offset:17408
    v_add_f32_dpp v14, v14, v14 row_half_mirror row_mask:0xf bank_mask:0xf
    v_add_f32_dpp v15, v15, v15 row_half_mirror row_mask:0xf bank_mask:0xf
    v_mfma_f32_16x16x32_bf16 v[224:227], v[32:35], v[28:31], 0
    ds_read_b64_tr_b16 v[84:85], v114 offset:18432
    s_add_u32 s60, s57, 32768
    s_cmp_ge_u32 s60, 98304
    s_cselect_b32 s57, 0, s60
    v_add_f32_dpp v14, v14, v14 row_mirror row_mask:0xf bank_mask:0xf
    v_add_f32_dpp v15, v15, v15 row_mirror row_mask:0xf bank_mask:0xf
    v_mfma_f32_16x16x32_bf16 v[228:231], v[36:39], v[28:31], 0
    ds_read_b64_tr_b16 v[86:87], v114 offset:19456
    buffer_load_dwordx4 v126, s[28:31], s54 offen offset:0 lds
    v_readlane_b32 s72, v14, 0
    v_readlane_b32 s76, v15, 0
    v_mfma_f32_16x16x32_bf16 v[196:199], v[36:39], v[24:27], 0
    ds_read_b64_tr_b16 v[88:89], v115 offset:16384
    s_add_u32 s60, s57, 32768
    s_cmp_ge_u32 s60, 98304
    s_cselect_b32 s61, 0, s60
    v_readlane_b32 s73, v14, 16
    v_readlane_b32 s77, v15, 16
    v_mfma_f32_16x16x32_bf16 v[164:167], v[36:39], v[20:23], 0
    ds_read_b64_tr_b16 v[90:91], v115 offset:17408
    v_readlane_b32 s74, v14, 32
    v_readlane_b32 s78, v15, 32
    v_mfma_f32_16x16x32_bf16 v[132:135], v[36:39], v[16:19], 0
    ds_read_b64_tr_b16 v[92:93], v115 offset:18432
    v_readlane_b32 s75, v14, 48
    v_readlane_b32 s79, v15, 48
    v_mfma_f32_16x16x32_bf16 v[136:139], v[40:43], v[16:19], 0
    ds_read_b64_tr_b16 v[94:95], v115 offset:19456
    buffer_load_dwordx4 v127, s[28:31], s54 offen offset:1024 lds
    s_nop 0
    v_mfma_f32_16x16x32_bf16 v[168:171], v[40:43], v[20:23], 0
    ds_read_b64_tr_b16 v[96:97], v116 offset:16384
    v_mov_b32 v14, s72
    v_mov_b32 v15, s76
    v_mfma_f32_16x16x32_bf16 v[200:203], v[40:43], v[24:27], 0
    ds_read_b64_tr_b16 v[98:99], v116 offset:17408
    v_add_f32 v14, s73, v14
    v_add_f32 v15, s77, v15
    v_mfma_f32_16x16x32_bf16 v[232:235], v[40:43], v[28:31], 0
    ds_read_b64_tr_b16 v[100:101], v116 offset:18432
    v_add_f32 v14, s74, v14
    v_add_f32 v15, s78, v15
    v_mfma_f32_16x16x32_bf16 v[236:239], v[44:47], v[28:31], 0
    ds_read_b64_tr_b16 v[102:103], v116 offset:19456
    buffer_load_dwordx4 v126, s[32:35], s54 offen offset:2048 lds
    v_add_f32 v14, s75, v14
    v_add_f32 v15, s79, v15
    v_mfma_f32_16x16x32_bf16 v[204:207], v[44:47], v[24:27], 0
    ds_read_b128 v[68:71], v113 offset:2048
    v_cmp_eq_u32 vcc, 1, v2
    v_mfma_f32_16x16x32_bf16 v[172:175], v[44:47], v[20:23], 0
    ds_read_b128 v[72:75], v113 offset:4096
    s_nop 0
    v_mfma_f32_16x16x32_bf16 v[140:143], v[44:47], v[16:19], 0
    ds_read_b128 v[76:79], v113 offset:6144
    v_cndmask_b32 v14, v14, v15, vcc
    v_mfma_f32_16x16x32_bf16 v[144:147], v[48:51], v[16:19], 0
    buffer_load_dwordx4 v127, s[32:35], s54 offen offset:3072 lds
    v_xor_b32 v112, 0x8000, v112
    v_cvt_pk_bf16_f32 v14, v14, v14
    v_mfma_f32_16x16x32_bf16 v[176:179], v[48:51], v[20:23], 0
    s_add_u32 s54, s54, 458752
    s_add_u32 s53, s53, 128
    v_xor_b32 v113, 0x8000, v113
    v_lshlrev_b32 v14, 16, v14
    v_mfma_f32_16x16x32_bf16 v[208:211], v[48:51], v[24:27], 0
    v_add_u32 v114, s61, v118
    v_mul_f32 v14, 0xbfb8aa3b, v14
    v_mfma_f32_16x16x32_bf16 v[240:243], v[48:51], v[28:31], 0
    v_add_u32 v115, s61, v119
    v_exp_f32 v14, v14
    v_mfma_f32_16x16x32_bf16 v[244:247], v[52:55], v[28:31], 0
    v_add_u32 v116, s61, v120
    v_add_f32 v14, 1.0, v14
    v_mfma_f32_16x16x32_bf16 v[212:215], v[52:55], v[24:27], 0
    v_rcp_f32 v14, v14
    v_mfma_f32_16x16x32_bf16 v[180:183], v[52:55], v[20:23], 0
    s_mov_b64 exec, s[94:95]
    buffer_load_dword v1, v0, s[96:99], s92 offen
    s_mov_b64 exec, -1
    s_add_u32 s92, s92, s93
    v_cvt_pk_bf16_f32 v14, v14, v14
    v_mfma_f32_16x16x32_bf16 v[148:151], v[52:55], v[16:19], 0
    v_lshlrev_b32 v14, 16, v14
    .p2align 6
L_loop_n3:
    s_mov_b32 m0, s56
    s_waitcnt vmcnt(5) lgkmcnt(0)
    s_barrier
    v_mfma_f32_16x16x32_bf16 v[128:131], v[80:83], v[64:67], v[128:131]
    ds_read_b128 v[16:19], v112 offset:0
    v_mfma_f32_16x16x32_bf16 v[160:163], v[80:83], v[68:71], v[160:163]
    ds_read_b64_tr_b16 v[32:33], v114 offset:0
    buffer_load_dwordx4 v122, s[24:27], s53 offen offset:0 lds
    v_mfma_f32_16x16x32_bf16 v[192:195], v[80:83], v[72:75], v[192:195]
    ds_read_b64_tr_b16 v[34:35], v114 offset:1024
    v_mfma_f32_16x16x32_bf16 v[224:227], v[80:83], v[76:79], v[224:227]
    ds_read_b64_tr_b16 v[36:37], v114 offset:2048
    v_mfma_f32_16x16x32_bf16 v[228:231], v[84:87], v[76:79], v[228:231]
    ds_read_b64_tr_b16 v[38:39], v114 offset:3072
    buffer_load_dwordx4 v123, s[24:27], s53 offen offset:1024 lds
    v_mfma_f32_16x16x32_bf16 v[196:199], v[84:87], v[72:75], v[196:199]
    ds_read_b64_tr_b16 v[40:41], v115 offset:0
    v_mfma_f32_16x16x32_bf16 v[164:167], v[84:87], v[68:71], v[164:167]
    ds_read_b64_tr_b16 v[42:43], v115 offset:1024
    v_mfma_f32_16x16x32_bf16 v[132:135], v[84:87], v[64:67], v[132:135]
    ds_read_b64_tr_b16 v[44:45], v115 offset:2048
    buffer_load_dwordx4 v124, s[24:27], s53 offen offset:2048 lds
    v_mfma_f32_16x16x32_bf16 v[136:139], v[88:91], v[64:67], v[136:139]
    ds_read_b64_tr_b16 v[46:47], v115 offset:3072
    v_mfma_f32_16x16x32_bf16 v[168:171], v[88:91], v[68:71], v[168:171]
    ds_read_b64_tr_b16 v[48:49], v116 offset:0
    v_mfma_f32_16x16x32_bf16 v[200:203], v[88:91], v[72:75], v[200:203]
    ds_read_b64_tr_b16 v[50:51], v116 offset:1024
    buffer_load_dwordx4 v125, s[24:27], s53 offen offset:3072 lds
    v_mfma_f32_16x16x32_bf16 v[232:235], v[88:91], v[76:79], v[232:235]
    ds_read_b64_tr_b16 v[52:53], v116 offset:2048
    v_mfma_f32_16x16x32_bf16 v[236:239], v[92:95], v[76:79], v[236:239]
    ds_read_b64_tr_b16 v[54:55], v116 offset:3072
    v_mfma_f32_16x16x32_bf16 v[204:207], v[92:95], v[72:75], v[204:207]
    ds_read_b128 v[20:23], v112 offset:2048
    v_mfma_f32_16x16x32_bf16 v[172:175], v[92:95], v[68:71], v[172:175]
    ds_read_b128 v[24:27], v112 offset:4096
    v_mfma_f32_16x16x32_bf16 v[140:143], v[92:95], v[64:67], v[140:143]
    ds_read_b128 v[28:31], v112 offset:6144
    v_mfma_f32_16x16x32_bf16 v[144:147], v[96:99], v[64:67], v[144:147]
    s_xor_b32 s56, s56, 0x8000
    v_mfma_f32_16x16x32_bf16 v[176:179], v[96:99], v[68:71], v[176:179]
    v_mfma_f32_16x16x32_bf16 v[208:211], v[96:99], v[72:75], v[208:211]
    v_mfma_f32_16x16x32_bf16 v[240:243], v[96:99], v[76:79], v[240:243]
    v_mfma_f32_16x16x32_bf16 v[244:247], v[100:103], v[76:79], v[244:247]
    v_mfma_f32_16x16x32_bf16 v[212:215], v[100:103], v[72:75], v[212:215]
    v_mfma_f32_16x16x32_bf16 v[180:183], v[100:103], v[68:71], v[180:183]
    v_mfma_f32_16x16x32_bf16 v[148:151], v[100:103], v[64:67], v[148:151]
    s_waitcnt lgkmcnt(0)
    v_mfma_f32_16x16x32_bf16 v[128:131], v[32:35], v[16:19], v[128:131]
    ds_read_b128 v[64:67], v113 offset:0
    v_mfma_f32_16x16x32_bf16 v[160:163], v[32:35], v[20:23], v[160:163]
    ds_read_b64_tr_b16 v[80:81], v114 offset:16384
    s_add_u32 m0, s57, s59
    v_mfma_f32_16x16x32_bf16 v[192:195], v[32:35], v[24:27], v[192:195]
    ds_read_b64_tr_b16 v[82:83], v114 offset:17408
    v_mfma_f32_16x16x32_bf16 v[224:227], v[32:35], v[28:31], v[224:227]
    ds_read_b64_tr_b16 v[84:85], v114 offset:18432
    s_add_u32 s60, s57, 32768
    s_cmp_ge_u32 s60, 98304
    s_cselect_b32 s57, 0, s60
    v_mfma_f32_16x16x32_bf16 v[228:231], v[36:39], v[28:31], v[228:231]
    ds_read_b64_tr_b16 v[86:87], v114 offset:19456
    buffer_load_dwordx4 v126, s[28:31], s54 offen offset:0 lds
    v_mfma_f32_16x16x32_bf16 v[196:199], v[36:39], v[24:27], v[196:199]
    ds_read_b64_tr_b16 v[88:89], v115 offset:16384
    s_add_u32 s60, s57, 32768
    s_cmp_ge_u32 s60, 98304
    s_cselect_b32 s61, 0, s60
    v_mfma_f32_16x16x32_bf16 v[164:167], v[36:39], v[20:23], v[164:167]
    ds_read_b64_tr_b16 v[90:91], v115 offset:17408
    v_mfma_f32_16x16x32_bf16 v[132:135], v[36:39], v[16:19], v[132:135]
    ds_read_b64_tr_b16 v[92:93], v115 offset:18432
    v_mfma_f32_16x16x32_bf16 v[136:139], v[40:43], v[16:19], v[136:139]
    ds_read_b64_tr_b16 v[94:95], v115 offset:19456
    buffer_load_dwordx4 v127, s[28:31], s54 offen offset:1024 lds
    v_mfma_f32_16x16x32_bf16 v[168:171], v[40:43], v[20:23], v[168:171]
    ds_read_b64_tr_b16 v[96:97], v116 offset:16384
    v_mfma_f32_16x16x32_bf16 v[200:203], v[40:43], v[24:27], v[200:203]
    ds_read_b64_tr_b16 v[98:99], v116 offset:17408
    v_mfma_f32_16x16x32_bf16 v[232:235], v[40:43], v[28:31], v[232:235]
    ds_read_b64_tr_b16 v[100:101], v116 offset:18432
    v_mfma_f32_16x16x32_bf16 v[236:239], v[44:47], v[28:31], v[236:239]
    ds_read_b64_tr_b16 v[102:103], v116 offset:19456
    buffer_load_dwordx4 v126, s[32:35], s54 offen offset:2048 lds
    v_mfma_f32_16x16x32_bf16 v[204:207], v[44:47], v[24:27], v[204:207]
    ds_read_b128 v[68:71], v113 offset:2048
    v_mfma_f32_16x16x32_bf16 v[172:175], v[44:47], v[20:23], v[172:175]
    ds_read_b128 v[72:75], v113 offset:4096
    v_mfma_f32_16x16x32_bf16 v[140:143], v[44:47], v[16:19], v[140:143]
    ds_read_b128 v[76:79], v113 offset:6144
    v_mfma_f32_16x16x32_bf16 v[144:147], v[48:51], v[16:19], v[144:147]
    buffer_load_dwordx4 v127, s[32:35], s54 offen offset:3072 lds
    v_xor_b32 v112, 0x8000, v112
    v_mfma_f32_16x16x32_bf16 v[176:179], v[48:51], v[20:23], v[176:179]
    s_add_u32 s54, s54, 458752
    s_add_u32 s53, s53, 128
    v_xor_b32 v113, 0x8000, v113
    v_mfma_f32_16x16x32_bf16 v[208:211], v[48:51], v[24:27], v[208:211]
    v_add_u32 v114, s61, v118
    v_mfma_f32_16x16x32_bf16 v[240:243], v[48:51], v[28:31], v[240:243]
    v_add_u32 v115, s61, v119
    v_mfma_f32_16x16x32_bf16 v[244:247], v[52:55], v[28:31], v[244:247]
    v_add_u32 v116, s61, v120
    v_mfma_f32_16x16x32_bf16 v[212:215], v[52:55], v[24:27], v[212:215]
    v_mfma_f32_16x16x32_bf16 v[180:183], v[52:55], v[20:23], v[180:183]
    s_mov_b64 exec, s[94:95]
    buffer_load_dword v1, v0, s[96:99], s92 offen
    s_mov_b64 exec, -1
    s_add_u32 s92, s92, s93
    v_mfma_f32_16x16x32_bf16 v[148:151], v[52:55], v[16:19], v[148:151]
    s_add_u32 s58, s58, 1
    s_cmp_lt_u32 s58, 13
    s_cbranch_scc1 L_loop_n3
    s_mov_b32 m0, s56
    s_waitcnt vmcnt(5) lgkmcnt(0)
    s_barrier
    v_mfma_f32_16x16x32_bf16 v[128:131], v[80:83], v[64:67], v[128:131]
    ds_read_b128 v[16:19], v112 offset:0
    buffer_load_dwordx4 v122, s[24:27], s53 offen offset:0 lds
    v_mfma_f32_16x16x32_bf16 v[160:163], v[80:83], v[68:71], v[160:163]
    ds_read_b64_tr_b16 v[32:33], v114 offset:0
    v_mfma_f32_16x16x32_bf16 v[192:195], v[80:83], v[72:75], v[192:195]
    ds_read_b64_tr_b16 v[34:35], v114 offset:1024
    buffer_load_dwordx4 v123, s[24:27], s53 offen offset:1024 lds
    v_mfma_f32_16x16x32_bf16 v[224:227], v[80:83], v[76:79], v[224:227]
    ds_read_b64_tr_b16 v[36:37], v114 offset:2048
    v_mfma_f32_16x16x32_bf16 v[228:231], v[84:87], v[76:79], v[228:231]
    ds_read_b64_tr_b16 v[38:39], v114 offset:3072
    buffer_load_dwordx4 v124, s[24:27], s53 offen offset:2048 lds
    v_mfma_f32_16x16x32_bf16 v[196:199], v[84:87], v[72:75], v[196:199]
    ds_read_b64_tr_b16 v[40:41], v115 offset:0
    v_mfma_f32_16x16x32_bf16 v[164:167], v[84:87], v[68:71], v[164:167]
    ds_read_b64_tr_b16 v[42:43], v115 offset:1024
    buffer_load_dwordx4 v125, s[24:27], s53 offen offset:3072 lds
    v_mfma_f32_16x16x32_bf16 v[132:135], v[84:87], v[64:67], v[132:135]
    ds_read_b64_tr_b16 v[44:45], v115 offset:2048
    v_mfma_f32_16x16x32_bf16 v[136:139], v[88:91], v[64:67], v[136:139]
    ds_read_b64_tr_b16 v[46:47], v115 offset:3072
    v_mfma_f32_16x16x32_bf16 v[168:171], v[88:91], v[68:71], v[168:171]
    ds_read_b64_tr_b16 v[48:49], v116 offset:0
    s_and_b32 s60, s2, 63
    s_lshl_b32 s60, s60, 2
    s_lshr_b32 s64, s2, 6
    s_add_u32 s60, s60, s64
    s_mul_i32 s60, s60, 16512
    s_add_u32 s60, s60, 0x01400000
    s_lshl_b32 s64, s48, 11
    s_add_u32 s64, s64, s60
    buffer_store_dwordx4 v[4:7], v3, s[36:39], s64 offen sc1
    buffer_store_dwordx4 v[8:11], v3, s[36:39], s64 offen offset:1024 sc1
    s_lshl_b32 s63, s70, 2
    s_add_u32 s63, s63, 0x01900000
    v_lshlrev_b32 v13, 8, v2
    s_mov_b64 exec, 3
    buffer_store_dword v14, v13, s[36:39], s63 offen sc1
    s_mov_b64 exec, -1
    s_mul_i32 s71, s50, 458752
    s_lshl_b32 s62, s49, 13
    s_and_b32 s63, s48, 3
    s_lshl_b32 s63, s63, 11
    s_add_u32 s62, s62, s63
    s_add_u32 s62, s62, s71
    s_add_u32 s64, s62, 0x00040000
    s_add_u32 s65, s64, 65536
    s_add_u32 s66, s64, 131072
    v_mfma_f32_16x16x32_bf16 v[200:203], v[88:91], v[72:75], v[200:203]
    ds_read_b64_tr_b16 v[50:51], v116 offset:1024
    v_mfma_f32_16x16x32_bf16 v[232:235], v[88:91], v[76:79], v[232:235]
    ds_read_b64_tr_b16 v[52:53], v116 offset:2048
    s_lshl_b32 s72, s49, 1
    s_lshr_b32 s73, s50, 4
    s_add_u32 s72, s72, s73
    s_lshl_b32 s72, s72, 4
    s_and_b32 s73, s50, 15
    s_add_u32 s72, s72, s73
    s_lshl_b32 s72, s72, 2
    v_mfma_f32_16x16x32_bf16 v[236:239], v[92:95], v[76:79], v[236:239]
    ds_read_b64_tr_b16 v[54:55], v116 offset:3072
    s_add_u32 s72, s72, 0x01913000
    s_and_b32 s74, s2, 7
    s_lshr_b32 s75, s2, 3
    s_lshr_b32 s76, s74, 1
    s_lshl_b32 s76, s76, 2
    s_lshr_b32 s77, s75, 3
    s_add_u32 s49, s76, s77
    v_mfma_f32_16x16x32_bf16 v[204:207], v[92:95], v[72:75], v[204:207]
    ds_read_b128 v[20:23], v112 offset:2048
    s_and_b32 s50, s75, 7
    s_and_b32 s51, s74, 1
    s_sub_u32 s74, s48, 4
    s_mul_i32 s75, s51, 7340032
    s_lshl_b32 s76, s49, 12
    s_add_u32 s75, s75, s76
    s_add_u32 s75, s75, 0x00000000
    v_mfma_f32_16x16x32_bf16 v[172:175], v[92:95], v[68:71], v[172:175]
    ds_read_b128 v[24:27], v112 offset:4096
    s_lshl_b32 s98, s74, 12
    v_lshlrev_b32 v56, 4, v2
    v_add_u32 v108, s75, v56
    s_lshl_b32 s76, s50, 2
    s_lshr_b32 s99, 0xeca86420, s76
    s_and_b32 s99, s99, 15
    s_lshr_b32 s100, 0xfdb97531, s76
    v_mfma_f32_16x16x32_bf16 v[140:143], v[92:95], v[64:67], v[140:143]
    ds_read_b128 v[28:31], v112 offset:6144
    s_and_b32 s100, s100, 15
    v_lshrrev_b32 v57, 4, v2
    v_lshlrev_b32 v58, 11, v57
    v_lshlrev_b32 v57, 1, v57
    v_and_b32 v59, 15, v2
    v_xor_b32 v57, v57, v59
    s_mul_i32 s75, s51, 3670016
    v_mfma_f32_16x16x32_bf16 v[144:147], v[96:99], v[64:67], v[144:147]
    s_xor_b32 s56, s56, 0x8000
    v_add_u32 v58, s75, v58
    v_and_b32 v59, 7, v57
    v_lshlrev_b32 v59, 4, v59
    v_add_u32 v58, v58, v59
    s_lshl_b32 s75, s99, 7
    s_lshl_b32 s76, s100, 7
    v_mov_b32 v59, s75
    v_mfma_f32_16x16x32_bf16 v[176:179], v[96:99], v[68:71], v[176:179]
    v_mov_b32 v60, s76
    v_cmp_gt_u32 vcc, 8, v57
    s_nop 1
    v_cndmask_b32 v61, v60, v59, vcc
    v_cndmask_b32 v62, v59, v60, vcc
    v_add_u32 v104, v58, v61
    v_add_u32 v105, v58, v62
    v_mfma_f32_16x16x32_bf16 v[208:211], v[96:99], v[72:75], v[208:211]
    v_add_u32 v105, 7168, v105
    v_add_u32 v106, 14336, v104
    v_add_u32 v107, 14336, v105
    s_lshr_b32 s75, s2, 3
    s_and_b32 s75, s75, 15
    s_mul_i32 s75, s75, 0
    s_add_u32 s75, s75, s74
    v_mfma_f32_16x16x32_bf16 v[240:243], v[96:99], v[76:79], v[240:243]
    s_lshl_b32 s97, s75, 16
    s_lshl_b32 s55, s75, 15
    s_mov_b32 s96, 98304
    s_mov_b32 s52, 0
    s_mov_b32 s28, s20
    s_and_b32 s29, s21, 0xffff
    s_mov_b32 s30, 0x00700000
    v_mfma_f32_16x16x32_bf16 v[244:247], v[100:103], v[76:79], v[244:247]
    s_mov_b32 s31, 0x20000
    s_mov_b32 s24, s8
    s_and_b32 s25, s9, 0xffff
    s_mov_b32 s26, 0x00400000
    s_mov_b32 s27, 0x20000
    v_mfma_f32_16x16x32_bf16 v[212:215], v[100:103], v[72:75], v[212:215]
    v_mfma_f32_16x16x32_bf16 v[180:183], v[100:103], v[68:71], v[180:183]
    v_mfma_f32_16x16x32_bf16 v[148:151], v[100:103], v[64:67], v[148:151]
    s_waitcnt lgkmcnt(0)
    v_mfma_f32_16x16x32_bf16 v[128:131], v[32:35], v[16:19], v[128:131]
    ds_read_b128 v[64:67], v113 offset:0
    v_mfma_f32_16x16x32_bf16 v[160:163], v[32:35], v[20:23], v[160:163]
    ds_read_b64_tr_b16 v[80:81], v114 offset:16384
    v_mfma_f32_16x16x32_bf16 v[192:195], v[32:35], v[24:27], v[192:195]
    ds_read_b64_tr_b16 v[82:83], v114 offset:17408
    v_mfma_f32_16x16x32_bf16 v[224:227], v[32:35], v[28:31], v[224:227]
    ds_read_b64_tr_b16 v[84:85], v114 offset:18432
    s_add_u32 s60, s57, 32768
    s_cmp_ge_u32 s60, 98304
    s_cselect_b32 s57, 0, s60
    v_mfma_f32_16x16x32_bf16 v[228:231], v[36:39], v[28:31], v[228:231]
    ds_read_b64_tr_b16 v[86:87], v114 offset:19456
    v_mfma_f32_16x16x32_bf16 v[196:199], v[36:39], v[24:27], v[196:199]
    ds_read_b64_tr_b16 v[88:89], v115 offset:16384
    s_add_u32 s60, s57, 32768
    s_cmp_ge_u32 s60, 98304
    s_cselect_b32 s61, 0, s60
    v_mfma_f32_16x16x32_bf16 v[164:167], v[36:39], v[20:23], v[164:167]
    ds_read_b64_tr_b16 v[90:91], v115 offset:17408
    v_mfma_f32_16x16x32_bf16 v[132:135], v[36:39], v[16:19], v[132:135]
    ds_read_b64_tr_b16 v[92:93], v115 offset:18432
    v_mfma_f32_16x16x32_bf16 v[136:139], v[40:43], v[16:19], v[136:139]
    ds_read_b64_tr_b16 v[94:95], v115 offset:19456
    v_mfma_f32_16x16x32_bf16 v[168:171], v[40:43], v[20:23], v[168:171]
    ds_read_b64_tr_b16 v[96:97], v116 offset:16384
    v_mfma_f32_16x16x32_bf16 v[200:203], v[40:43], v[24:27], v[200:203]
    ds_read_b64_tr_b16 v[98:99], v116 offset:17408
    v_mfma_f32_16x16x32_bf16 v[232:235], v[40:43], v[28:31], v[232:235]
    ds_read_b64_tr_b16 v[100:101], v116 offset:18432
    v_mfma_f32_16x16x32_bf16 v[236:239], v[44:47], v[28:31], v[236:239]
    ds_read_b64_tr_b16 v[102:103], v116 offset:19456
    v_mfma_f32_16x16x32_bf16 v[204:207], v[44:47], v[24:27], v[204:207]
    ds_read_b128 v[68:71], v113 offset:2048
    v_mfma_f32_16x16x32_bf16 v[172:175], v[44:47], v[20:23], v[172:175]
    ds_read_b128 v[72:75], v113 offset:4096
    v_mfma_f32_16x16x32_bf16 v[140:143], v[44:47], v[16:19], v[140:143]
    ds_read_b128 v[76:79], v113 offset:6144
    v_mfma_f32_16x16x32_bf16 v[144:147], v[48:51], v[16:19], v[144:147]
    v_xor_b32 v112, 0x8000, v112
    v_mfma_f32_16x16x32_bf16 v[176:179], v[48:51], v[20:23], v[176:179]
    v_xor_b32 v113, 0x8000, v113
    v_mfma_f32_16x16x32_bf16 v[208:211], v[48:51], v[24:27], v[208:211]
    v_add_u32 v114, s61, v118
    v_mfma_f32_16x16x32_bf16 v[240:243], v[48:51], v[28:31], v[240:243]
    v_add_u32 v115, s61, v119
    v_mfma_f32_16x16x32_bf16 v[244:247], v[52:55], v[28:31], v[244:247]
    v_add_u32 v116, s61, v120
    v_mfma_f32_16x16x32_bf16 v[212:215], v[52:55], v[24:27], v[212:215]
    s_mov_b32 s40, s20
    s_and_b32 s41, s21, 0xffff
    s_mov_b32 s42, 0x00700000
    s_mov_b32 s43, 0x20000
    s_mul_i32 s62, s2, 28672
    s_mul_i32 s63, s48, 3584
    s_add_u32 s62, s62, s63
    v_lshlrev_b32 v0, 7, v2
    s_mov_b64 exec, 0xfffffff
    buffer_load_dword v1, v0, s[40:43], s62 offen
    s_mov_b64 exec, -1
    v_mfma_f32_16x16x32_bf16 v[180:183], v[52:55], v[20:23], v[180:183]
    v_mfma_f32_16x16x32_bf16 v[148:151], v[52:55], v[16:19], v[148:151]
    s_mov_b32 m0, s56
    s_waitcnt vmcnt(4) lgkmcnt(0)
    s_barrier
    v_mfma_f32_16x16x32_bf16 v[128:131], v[80:83], v[64:67], v[128:131]
    ds_read_b128 v[16:19], v112 offset:0
    v_mfma_f32_16x16x32_bf16 v[160:163], v[80:83], v[68:71], v[160:163]
    ds_read_b64_tr_b16 v[32:33], v114 offset:0
    v_mfma_f32_16x16x32_bf16 v[192:195], v[80:83], v[72:75], v[192:195]
    ds_read_b64_tr_b16 v[34:35], v114 offset:1024
    v_mfma_f32_16x16x32_bf16 v[224:227], v[80:83], v[76:79], v[224:227]
    ds_read_b64_tr_b16 v[36:37], v114 offset:2048
    v_mfma_f32_16x16x32_bf16 v[228:231], v[84:87], v[76:79], v[228:231]
    ds_read_b64_tr_b16 v[38:39], v114 offset:3072
    v_mfma_f32_16x16x32_bf16 v[196:199], v[84:87], v[72:75], v[196:199]
    ds_read_b64_tr_b16 v[40:41], v115 offset:0
    v_mfma_f32_16x16x32_bf16 v[164:167], v[84:87], v[68:71], v[164:167]
    ds_read_b64_tr_b16 v[42:43], v115 offset:1024
    v_mfma_f32_16x16x32_bf16 v[132:135], v[84:87], v[64:67], v[132:135]
    ds_read_b64_tr_b16 v[44:45], v115 offset:2048
    v_mfma_f32_16x16x32_bf16 v[136:139], v[88:91], v[64:67], v[136:139]
    ds_read_b64_tr_b16 v[46:47], v115 offset:3072
    v_mfma_f32_16x16x32_bf16 v[168:171], v[88:91], v[68:71], v[168:171]
    ds_read_b64_tr_b16 v[48:49], v116 offset:0
    v_mfma_f32_16x16x32_bf16 v[200:203], v[88:91], v[72:75], v[200:203]
    ds_read_b64_tr_b16 v[50:51], v116 offset:1024
    v_mov_b32 v14, 0xc0135761
    v_mov_b32 v15, 0xc0135761
    s_mov_b32 s60, 0xbdd2d3e8
    s_mov_b32 s61, 0xbdd2d3e8
    s_mov_b32 s68, 0xffff0000
    s_mov_b32 s69, 0xffff0000
    v_mfma_f32_16x16x32_bf16 v[232:235], v[88:91], v[76:79], v[232:235]
    ds_read_b64_tr_b16 v[52:53], v116 offset:2048
    v_mfma_f32_16x16x32_bf16 v[236:239], v[92:95], v[76:79], v[236:239]
    ds_read_b64_tr_b16 v[54:55], v116 offset:3072
    v_mfma_f32_16x16x32_bf16 v[204:207], v[92:95], v[72:75], v[204:207]
    ds_read_b128 v[20:23], v112 offset:2048
    v_mfma_f32_16x16x32_bf16 v[172:175], v[92:95], v[68:71], v[172:175]
    ds_read_b128 v[24:27], v112 offset:4096
    v_mfma_f32_16x16x32_bf16 v[140:143], v[92:95], v[64:67], v[140:143]
    ds_read_b128 v[28:31], v112 offset:6144
    v_mfma_f32_16x16x32_bf16 v[144:147], v[96:99], v[64:67], v[144:147]
    v_mfma_f32_16x16x32_bf16 v[176:179], v[96:99], v[68:71], v[176:179]
    v_mfma_f32_16x16x32_bf16 v[208:211], v[96:99], v[72:75], v[208:211]
    v_mfma_f32_16x16x32_bf16 v[240:243], v[96:99], v[76:79], v[240:243]
    v_mfma_f32_16x16x32_bf16 v[244:247], v[100:103], v[76:79], v[244:247]
    v_mfma_f32_16x16x32_bf16 v[212:215], v[100:103], v[72:75], v[212:215]
    v_mfma_f32_16x16x32_bf16 v[180:183], v[100:103], v[68:71], v[180:183]
    v_mfma_f32_16x16x32_bf16 v[148:151], v[100:103], v[64:67], v[148:151]
    s_waitcnt lgkmcnt(0)
    v_mfma_f32_16x16x32_bf16 v[128:131], v[32:35], v[16:19], v[128:131]
    ds_read_b128 v[64:67], v113 offset:0
    ds_read_b64_tr_b16 v[80:81], v114 offset:16384
    v_mfma_f32_16x16x32_bf16 v[132:135], v[36:39], v[16:19], v[132:135]
    ds_read_b64_tr_b16 v[82:83], v114 offset:17408
    ds_read_b64_tr_b16 v[84:85], v114 offset:18432
    v_mfma_f32_16x16x32_bf16 v[136:139], v[40:43], v[16:19], v[136:139]
    ds_read_b64_tr_b16 v[86:87], v114 offset:19456
    ds_read_b64_tr_b16 v[88:89], v115 offset:16384
    v_mfma_f32_16x16x32_bf16 v[140:143], v[44:47], v[16:19], v[140:143]
    ds_read_b64_tr_b16 v[90:91], v115 offset:17408
    ds_read_b64_tr_b16 v[92:93], v115 offset:18432
    v_mfma_f32_16x16x32_bf16 v[144:147], v[48:51], v[16:19], v[144:147]
    ds_read_b64_tr_b16 v[94:95], v115 offset:19456
    ds_read_b64_tr_b16 v[96:97], v116 offset:16384
    v_mfma_f32_16x16x32_bf16 v[148:151], v[52:55], v[16:19], v[148:151]
    ds_read_b64_tr_b16 v[98:99], v116 offset:17408
    ds_read_b64_tr_b16 v[100:101], v116 offset:18432
    v_mfma_f32_16x16x32_bf16 v[180:183], v[52:55], v[20:23], v[180:183]
    ds_read_b64_tr_b16 v[102:103], v116 offset:19456
    ds_read_b128 v[68:71], v113 offset:2048
    v_mfma_f32_16x16x32_bf16 v[176:179], v[48:51], v[20:23], v[176:179]
    ds_read_b128 v[72:75], v113 offset:4096
    ds_read_b128 v[76:79], v113 offset:6144
    v_mfma_f32_16x16x32_bf16 v[172:175], v[44:47], v[20:23], v[172:175]
    v_mfma_f32_16x16x32_bf16 v[168:171], v[40:43], v[20:23], v[168:171]
    v_mfma_f32_16x16x32_bf16 v[164:167], v[36:39], v[20:23], v[164:167]
    v_mfma_f32_16x16x32_bf16 v[160:163], v[32:35], v[20:23], v[160:163]
    s_waitcnt vmcnt(1) lgkmcnt(0)
    s_barrier
    s_cmp_lg_u32 s48, 7
    s_cbranch_scc1 L_nozf
    s_lshl_b32 s62, s2, 2
    s_add_u32 s62, s62, 0x01912000
    v_mov_b32 v4, s44
    s_mov_b64 exec, 1
    buffer_store_dword v4, v3, s[36:39], s62 offen sc1
    s_mov_b64 exec, -1
L_nozf:
    v_mfma_f32_16x16x32_bf16 v[128:131], v[80:83], v[64:67], v[128:131]
    v_mfma_f32_16x16x32_bf16 v[132:135], v[84:87], v[64:67], v[132:135]
    v_mfma_f32_16x16x32_bf16 v[136:139], v[88:91], v[64:67], v[136:139]
    v_mfma_f32_16x16x32_bf16 v[140:143], v[92:95], v[64:67], v[140:143]
    v_mfma_f32_16x16x32_bf16 v[144:147], v[96:99], v[64:67], v[144:147]
    v_mfma_f32_16x16x32_bf16 v[148:151], v[100:103], v[64:67], v[148:151]
    v_mfma_f32_16x16x32_bf16 v[180:183], v[100:103], v[68:71], v[180:183]
    v_mfma_f32_16x16x32_bf16 v[176:179], v[96:99], v[68:71], v[176:179]
    v_mfma_f32_16x16x32_bf16 v[172:175], v[92:95], v[68:71], v[172:175]
    v_mfma_f32_16x16x32_bf16 v[168:171], v[88:91], v[68:71], v[168:171]
    s_nop 3
    v_pk_mul_f32 v[4:5], v[128:129], v[128:129]
    v_pk_mul_f32 v[6:7], v[130:131], v[130:131]
    v_pk_mul_f32 v[8:9], v[136:137], v[136:137]
    v_pk_mul_f32 v[10:11], v[138:139], v[138:139]
    v_pk_fma_f32 v[4:5], v[4:5], s[60:61], v[14:15]
    v_pk_fma_f32 v[6:7], v[6:7], s[60:61], v[14:15]
    v_pk_fma_f32 v[8:9], v[8:9], s[60:61], v[14:15]
    v_mfma_f32_16x16x32_bf16 v[164:167], v[84:87], v[68:71], v[164:167]
    v_pk_fma_f32 v[10:11], v[10:11], s[60:61], v[14:15]
    v_pk_mul_f32 v[4:5], v[4:5], v[128:129]
    v_pk_mul_f32 v[6:7], v[6:7], v[130:131]
    v_pk_mul_f32 v[8:9], v[8:9], v[136:137]
    v_pk_mul_f32 v[10:11], v[10:11], v[138:139]
    v_exp_f32 v4, v4
    v_exp_f32 v5, v5
    v_mfma_f32_16x16x32_bf16 v[160:163], v[80:83], v[68:71], v[160:163]
    v_exp_f32 v6, v6
    v_exp_f32 v7, v7
    v_exp_f32 v8, v8
    v_exp_f32 v9, v9
    v_exp_f32 v10, v10
    v_exp_f32 v11, v11
    v_pk_mul_f32 v[132:133], v[128:129], v[132:133]
    v_mfma_f32_16x16x32_bf16 v[192:195], v[32:35], v[24:27], v[192:195]
    v_pk_mul_f32 v[134:135], v[130:131], v[134:135]
    v_pk_mul_f32 v[140:141], v[136:137], v[140:141]
    v_pk_mul_f32 v[142:143], v[138:139], v[142:143]
    v_pk_add_f32 v[4:5], v[4:5], 1.0 op_sel_hi:[1,0]
    v_pk_add_f32 v[6:7], v[6:7], 1.0 op_sel_hi:[1,0]
    v_pk_add_f32 v[8:9], v[8:9], 1.0 op_sel_hi:[1,0]
    v_pk_add_f32 v[10:11], v[10:11], 1.0 op_sel_hi:[1,0]
    v_mfma_f32_16x16x32_bf16 v[196:199], v[36:39], v[24:27], v[196:199]
    v_rcp_f32 v4, v4
    v_rcp_f32 v5, v5
    v_rcp_f32 v6, v6
    v_rcp_f32 v7, v7
    v_rcp_f32 v8, v8
    v_rcp_f32 v9, v9
    v_rcp_f32 v10, v10
    v_mfma_f32_16x16x32_bf16 v[200:203], v[40:43], v[24:27], v[200:203]
    v_rcp_f32 v11, v11
    s_nop 0
    v_pk_mul_f32 v[132:133], v[132:133], v[4:5]
    v_pk_mul_f32 v[134:135], v[134:135], v[6:7]
    v_pk_mul_f32 v[140:141], v[140:141], v[8:9]
    v_pk_mul_f32 v[142:143], v[142:143], v[10:11]
    v_cvt_pk_bf16_f32 v128, v132, v133
    v_mfma_f32_16x16x32_bf16 v[204:207], v[44:47], v[24:27], v[204:207]
    v_cvt_pk_bf16_f32 v129, v134, v135
    v_cvt_pk_bf16_f32 v136, v140, v141
    v_cvt_pk_bf16_f32 v137, v142, v143
    v_pk_mul_f32 v[120:121], v[144:145], v[144:145]
    v_pk_mul_f32 v[122:123], v[146:147], v[146:147]
    v_pk_fma_f32 v[120:121], v[120:121], s[60:61], v[14:15]
    v_pk_fma_f32 v[122:123], v[122:123], s[60:61], v[14:15]
    v_mfma_f32_16x16x32_bf16 v[208:211], v[48:51], v[24:27], v[208:211]
    v_pk_mul_f32 v[120:121], v[120:121], v[144:145]
    v_pk_mul_f32 v[122:123], v[122:123], v[146:147]
    v_exp_f32 v120, v120
    v_exp_f32 v121, v121
    v_exp_f32 v122, v122
    v_exp_f32 v123, v123
    v_pk_mul_f32 v[148:149], v[144:145], v[148:149]
    v_mfma_f32_16x16x32_bf16 v[212:215], v[52:55], v[24:27], v[212:215]
    v_pk_mul_f32 v[150:151], v[146:147], v[150:151]
    v_pk_add_f32 v[120:121], v[120:121], 1.0 op_sel_hi:[1,0]
    v_pk_add_f32 v[122:123], v[122:123], 1.0 op_sel_hi:[1,0]
    v_rcp_f32 v120, v120
    v_rcp_f32 v121, v121
    v_rcp_f32 v122, v122
    v_rcp_f32 v123, v123
    s_nop 0
    v_pk_mul_f32 v[148:149], v[148:149], v[120:121]
    v_pk_mul_f32 v[150:151], v[150:151], v[122:123]
    v_cvt_pk_bf16_f32 v144, v148, v149
    v_cvt_pk_bf16_f32 v145, v150, v151
    v_mfma_f32_16x16x32_bf16 v[192:195], v[80:83], v[72:75], v[192:195]
    v_mfma_f32_16x16x32_bf16 v[196:199], v[84:87], v[72:75], v[196:199]
    v_mfma_f32_16x16x32_bf16 v[200:203], v[88:91], v[72:75], v[200:203]
    v_mfma_f32_16x16x32_bf16 v[204:207], v[92:95], v[72:75], v[204:207]
    s_nop 3
    v_pk_mul_f32 v[4:5], v[160:161], v[160:161]
    v_pk_mul_f32 v[6:7], v[162:163], v[162:163]
    v_pk_mul_f32 v[8:9], v[168:169], v[168:169]
    v_pk_mul_f32 v[10:11], v[170:171], v[170:171]
    v_pk_fma_f32 v[4:5], v[4:5], s[60:61], v[14:15]
    v_pk_fma_f32 v[6:7], v[6:7], s[60:61], v[14:15]
    v_pk_fma_f32 v[8:9], v[8:9], s[60:61], v[14:15]
    v_pk_fma_f32 v[10:11], v[10:11], s[60:61], v[14:15]
    v_mfma_f32_16x16x32_bf16 v[208:211], v[96:99], v[72:75], v[208:211]
    v_pk_mul_f32 v[4:5], v[4:5], v[160:161]
    v_pk_mul_f32 v[6:7], v[6:7], v[162:163]
    v_pk_mul_f32 v[8:9], v[8:9], v[168:169]
    v_pk_mul_f32 v[10:11], v[10:11], v[170:171]
    v_exp_f32 v4, v4
    v_exp_f32 v5, v5
    v_exp_f32 v6, v6
    v_exp_f32 v7, v7
    v_mfma_f32_16x16x32_bf16 v[212:215], v[100:103], v[72:75], v[212:215]
    v_exp_f32 v8, v8
    v_exp_f32 v9, v9
    v_exp_f32 v10, v10
    v_exp_f32 v11, v11
    v_pk_mul_f32 v[164:165], v[160:161], v[164:165]
    v_pk_mul_f32 v[166:167], v[162:163], v[166:167]
    v_pk_mul_f32 v[172:173], v[168:169], v[172:173]
    v_pk_mul_f32 v[174:175], v[170:171], v[174:175]
    v_mfma_f32_16x16x32_bf16 v[244:247], v[52:55], v[28:31], v[244:247]
    v_pk_add_f32 v[4:5], v[4:5], 1.0 op_sel_hi:[1,0]
    v_pk_add_f32 v[6:7], v[6:7], 1.0 op_sel_hi:[1,0]
    v_pk_add_f32 v[8:9], v[8:9], 1.0 op_sel_hi:[1,0]
    v_pk_add_f32 v[10:11], v[10:11], 1.0 op_sel_hi:[1,0]
    v_rcp_f32 v4, v4
    v_rcp_f32 v5, v5
    v_rcp_f32 v6, v6
    v_rcp_f32 v7, v7
    v_mfma_f32_16x16x32_bf16 v[240:243], v[48:51], v[28:31], v[240:243]
    v_rcp_f32 v8, v8
    v_rcp_f32 v9, v9
    v_rcp_f32 v10, v10
    v_rcp_f32 v11, v11
    s_nop 0
    v_pk_mul_f32 v[164:165], v[164:165], v[4:5]
    v_pk_mul_f32 v[166:167], v[166:167], v[6:7]
    v_pk_mul_f32 v[172:173], v[172:173], v[8:9]
    v_mfma_f32_16x16x32_bf16 v[236:239], v[44:47], v[28:31], v[236:239]
    v_pk_mul_f32 v[174:175], v[174:175], v[10:11]
    v_cvt_pk_bf16_f32 v130, v164, v165
    v_cvt_pk_bf16_f32 v131, v166, v167
    s_mov_b64 exec, s[68:69]
    v_swap_b32 v128, v130
    v_swap_b32 v129, v131
    s_mov_b64 exec, -1
    buffer_store_dwordx4 v[128:131], v3, s[36:39], s64 offen offset:0 sc1
    v_cvt_pk_bf16_f32 v138, v172, v173
    v_cvt_pk_bf16_f32 v139, v174, v175
    s_mov_b64 exec, s[68:69]
    v_swap_b32 v136, v138
    v_swap_b32 v137, v139
    s_mov_b64 exec, -1
    v_mfma_f32_16x16x32_bf16 v[232:235], v[40:43], v[28:31], v[232:235]
    buffer_store_dwordx4 v[136:139], v3, s[36:39], s65 offen offset:0 sc1
    v_pk_mul_f32 v[120:121], v[176:177], v[176:177]
    v_pk_mul_f32 v[122:123], v[178:179], v[178:179]
    v_pk_fma_f32 v[120:121], v[120:121], s[60:61], v[14:15]
    v_pk_fma_f32 v[122:123], v[122:123], s[60:61], v[14:15]
    v_pk_mul_f32 v[120:121], v[120:121], v[176:177]
    v_pk_mul_f32 v[122:123], v[122:123], v[178:179]
    v_exp_f32 v120, v120
    v_mfma_f32_16x16x32_bf16 v[228:231], v[36:39], v[28:31], v[228:231]
    v_exp_f32 v121, v121
    v_exp_f32 v122, v122
    v_exp_f32 v123, v123
    v_pk_mul_f32 v[180:181], v[176:177], v[180:181]
    v_pk_mul_f32 v[182:183], v[178:179], v[182:183]
    v_pk_add_f32 v[120:121], v[120:121], 1.0 op_sel_hi:[1,0]
    v_pk_add_f32 v[122:123], v[122:123], 1.0 op_sel_hi:[1,0]
    v_rcp_f32 v120, v120
    v_mfma_f32_16x16x32_bf16 v[224:227], v[32:35], v[28:31], v[224:227]
    v_rcp_f32 v121, v121
    v_rcp_f32 v122, v122
    v_rcp_f32 v123, v123
    s_nop 0
    v_pk_mul_f32 v[180:181], v[180:181], v[120:121]
    v_pk_mul_f32 v[182:183], v[182:183], v[122:123]
    v_cvt_pk_bf16_f32 v146, v180, v181
    v_cvt_pk_bf16_f32 v147, v182, v183
    s_mov_b64 exec, s[68:69]
    v_swap_b32 v144, v146
    v_swap_b32 v145, v147
    s_mov_b64 exec, -1
    buffer_store_dwordx4 v[144:147], v3, s[36:39], s66 offen offset:0 sc1
    v_mfma_f32_16x16x32_bf16 v[244:247], v[100:103], v[76:79], v[244:247]
    v_mfma_f32_16x16x32_bf16 v[240:243], v[96:99], v[76:79], v[240:243]
    v_mfma_f32_16x16x32_bf16 v[236:239], v[92:95], v[76:79], v[236:239]
    v_mfma_f32_16x16x32_bf16 v[232:235], v[88:91], v[76:79], v[232:235]
    s_nop 3
    v_pk_mul_f32 v[4:5], v[192:193], v[192:193]
    v_pk_mul_f32 v[6:7], v[194:195], v[194:195]
    v_pk_mul_f32 v[8:9], v[200:201], v[200:201]
    v_pk_mul_f32 v[10:11], v[202:203], v[202:203]
    v_pk_fma_f32 v[4:5], v[4:5], s[60:61], v[14:15]
    v_pk_fma_f32 v[6:7], v[6:7], s[60:61], v[14:15]
    v_pk_fma_f32 v[8:9], v[8:9], s[60:61], v[14:15]
    v_pk_fma_f32 v[10:11], v[10:11], s[60:61], v[14:15]
    v_pk_mul_f32 v[4:5], v[4:5], v[192:193]
    v_pk_mul_f32 v[6:7], v[6:7], v[194:195]
    v_pk_mul_f32 v[8:9], v[8:9], v[200:201]
    v_pk_mul_f32 v[10:11], v[10:11], v[202:203]
    v_exp_f32 v4, v4
    v_exp_f32 v5, v5
    v_exp_f32 v6, v6
    v_exp_f32 v7, v7
    v_exp_f32 v8, v8
    v_exp_f32 v9, v9
    v_exp_f32 v10, v10
    v_exp_f32 v11, v11
    v_pk_mul_f32 v[196:197], v[192:193], v[196:197]
    v_pk_mul_f32 v[198:199], v[194:195], v[198:199]
    v_mfma_f32_16x16x32_bf16 v[228:231], v[84:87], v[76:79], v[228:231]
    v_pk_mul_f32 v[204:205], v[200:201], v[204:205]
    v_pk_mul_f32 v[206:207], v[202:203], v[206:207]
    v_pk_add_f32 v[4:5], v[4:5], 1.0 op_sel_hi:[1,0]
    v_pk_add_f32 v[6:7], v[6:7], 1.0 op_sel_hi:[1,0]
    v_pk_add_f32 v[8:9], v[8:9], 1.0 op_sel_hi:[1,0]
    v_pk_add_f32 v[10:11], v[10:11], 1.0 op_sel_hi:[1,0]
    v_rcp_f32 v4, v4
    v_rcp_f32 v5, v5
    v_rcp_f32 v6, v6
    v_rcp_f32 v7, v7
    v_rcp_f32 v8, v8
    v_rcp_f32 v9, v9
    v_rcp_f32 v10, v10
    v_rcp_f32 v11, v11
    s_nop 0
    v_pk_mul_f32 v[196:197], v[196:197], v[4:5]
    v_pk_mul_f32 v[198:199], v[198:199], v[6:7]
    v_pk_mul_f32 v[204:205], v[204:205], v[8:9]
    v_pk_mul_f32 v[206:207], v[206:207], v[10:11]
    v_cvt_pk_bf16_f32 v192, v196, v197
    v_cvt_pk_bf16_f32 v193, v198, v199
    v_cvt_pk_bf16_f32 v200, v204, v205
    v_mfma_f32_16x16x32_bf16 v[224:227], v[80:83], v[76:79], v[224:227]
    v_cvt_pk_bf16_f32 v201, v206, v207
    v_pk_mul_f32 v[120:121], v[208:209], v[208:209]
    v_pk_mul_f32 v[122:123], v[210:211], v[210:211]
    v_pk_fma_f32 v[120:121], v[120:121], s[60:61], v[14:15]
    v_pk_fma_f32 v[122:123], v[122:123], s[60:61], v[14:15]
    v_pk_mul_f32 v[120:121], v[120:121], v[208:209]
    v_pk_mul_f32 v[122:123], v[122:123], v[210:211]
    v_exp_f32 v120, v120
    v_exp_f32 v121, v121
    v_exp_f32 v122, v122
    v_exp_f32 v123, v123
    v_pk_mul_f32 v[212:213], v[208:209], v[212:213]
    v_pk_mul_f32 v[214:215], v[210:211], v[214:215]
    v_pk_add_f32 v[120:121], v[120:121], 1.0 op_sel_hi:[1,0]
    v_pk_add_f32 v[122:123], v[122:123], 1.0 op_sel_hi:[1,0]
    v_rcp_f32 v120, v120
    v_rcp_f32 v121, v121
    v_rcp_f32 v122, v122
    v_rcp_f32 v123, v123
    s_nop 0
    v_pk_mul_f32 v[212:213], v[212:213], v[120:121]
    v_pk_mul_f32 v[214:215], v[214:215], v[122:123]
    v_cvt_pk_bf16_f32 v208, v212, v213
    v_cvt_pk_bf16_f32 v209, v214, v215
    s_nop 7
    v_pk_mul_f32 v[4:5], v[224:225], v[224:225]
    v_pk_mul_f32 v[6:7], v[226:227], v[226:227]
    v_pk_mul_f32 v[8:9], v[232:233], v[232:233]
    v_pk_mul_f32 v[10:11], v[234:235], v[234:235]
    v_pk_fma_f32 v[4:5], v[4:5], s[60:61], v[14:15]
    v_pk_fma_f32 v[6:7], v[6:7], s[60:61], v[14:15]
    v_pk_fma_f32 v[8:9], v[8:9], s[60:61], v[14:15]
    v_pk_fma_f32 v[10:11], v[10:11], s[60:61], v[14:15]
    v_pk_mul_f32 v[4:5], v[4:5], v[224:225]
    v_pk_mul_f32 v[6:7], v[6:7], v[226:227]
    v_pk_mul_f32 v[8:9], v[8:9], v[232:233]
    v_pk_mul_f32 v[10:11], v[10:11], v[234:235]
    v_exp_f32 v4, v4
    v_exp_f32 v5, v5
    v_exp_f32 v6, v6
    v_exp_f32 v7, v7
    v_exp_f32 v8, v8
    v_exp_f32 v9, v9
    v_exp_f32 v10, v10
    v_exp_f32 v11, v11
    v_pk_mul_f32 v[228:229], v[224:225], v[228:229]
    v_pk_mul_f32 v[230:231], v[226:227], v[230:231]
    v_pk_mul_f32 v[236:237], v[232:233], v[236:237]
    v_pk_mul_f32 v[238:239], v[234:235], v[238:239]
    v_pk_add_f32 v[4:5], v[4:5], 1.0 op_sel_hi:[1,0]
    v_pk_add_f32 v[6:7], v[6:7], 1.0 op_sel_hi:[1,0]
    v_pk_add_f32 v[8:9], v[8:9], 1.0 op_sel_hi:[1,0]
    v_pk_add_f32 v[10:11], v[10:11], 1.0 op_sel_hi:[1,0]
    v_rcp_f32 v4, v4
    v_rcp_f32 v5, v5
    v_rcp_f32 v6, v6
    v_rcp_f32 v7, v7
    v_rcp_f32 v8, v8
    v_rcp_f32 v9, v9
    v_rcp_f32 v10, v10
    v_rcp_f32 v11, v11
    s_nop 0
    v_pk_mul_f32 v[228:229], v[228:229], v[4:5]
    v_pk_mul_f32 v[230:231], v[230:231], v[6:7]
    v_pk_mul_f32 v[236:237], v[236:237], v[8:9]
    v_pk_mul_f32 v[238:239], v[238:239], v[10:11]
    v_cvt_pk_bf16_f32 v194, v228, v229
    v_cvt_pk_bf16_f32 v195, v230, v231
    s_mov_b64 exec, s[68:69]
    v_swap_b32 v192, v194
    v_swap_b32 v193, v195
    s_mov_b64 exec, -1
    buffer_store_dwordx4 v[192:195], v3, s[36:39], s64 offen offset:1024 sc1
    v_cvt_pk_bf16_f32 v202, v236, v237
    v_cvt_pk_bf16_f32 v203, v238, v239
    s_mov_b64 exec, s[68:69]
    v_swap_b32 v200, v202
    v_swap_b32 v201, v203
    s_mov_b64 exec, -1
    buffer_store_dwordx4 v[200:203], v3, s[36:39], s65 offen offset:1024 sc1
    v_pk_mul_f32 v[120:121], v[240:241], v[240:241]
    v_pk_mul_f32 v[122:123], v[242:243], v[242:243]
    v_pk_fma_f32 v[120:121], v[120:121], s[60:61], v[14:15]
    v_pk_fma_f32 v[122:123], v[122:123], s[60:61], v[14:15]
    v_pk_mul_f32 v[120:121], v[120:121], v[240:241]
    v_pk_mul_f32 v[122:123], v[122:123], v[242:243]
    v_exp_f32 v120, v120
    v_exp_f32 v121, v121
    v_exp_f32 v122, v122
    v_exp_f32 v123, v123
    v_pk_mul_f32 v[244:245], v[240:241], v[244:245]
    v_pk_mul_f32 v[246:247], v[242:243], v[246:247]
    v_pk_add_f32 v[120:121], v[120:121], 1.0 op_sel_hi:[1,0]
    v_pk_add_f32 v[122:123], v[122:123], 1.0 op_sel_hi:[1,0]
    v_rcp_f32 v120, v120
    v_rcp_f32 v121, v121
    v_rcp_f32 v122, v122
    v_rcp_f32 v123, v123
    s_nop 0
    v_pk_mul_f32 v[244:245], v[244:245], v[120:121]
    v_pk_mul_f32 v[246:247], v[246:247], v[122:123]
    v_cvt_pk_bf16_f32 v210, v244, v245
    v_cvt_pk_bf16_f32 v211, v246, v247
    s_mov_b64 exec, s[68:69]
    v_swap_b32 v208, v210
    v_swap_b32 v209, v211
    s_mov_b64 exec, -1
    buffer_store_dwordx4 v[208:211], v3, s[36:39], s66 offen offset:1024 sc1
    s_setprio 0
    s_sub_u32 s60, s48, 4
    s_lshr_b32 s73, s49, 1
    s_lshl_b32 s73, s73, 1
    s_add_u32 s73, s73, s51
    s_lshl_b32 s73, s73, 6
    s_add_u32 s73, s73, 0x01913000
    v_and_b32 v9, 15, v2
    v_lshlrev_b32 v9, 2, v9
    v_mov_b32 v10, s44
    s_waitcnt vmcnt(0)
    s_barrier
    s_cmp_lg_u32 s48, 4
    s_cbranch_scc1 L_f_nohf
    s_mov_b64 exec, 1
    buffer_store_dword v10, v9, s[36:39], s72 offen sc1
    s_mov_b64 exec, -1
L_f_nohf:
    s_add_u32 m0, s98, 114688
    s_nop 0
    buffer_load_dwordx4 v104, s[28:31], s55 offen offset:0 lds
    buffer_load_dwordx4 v105, s[28:31], s55 offen offset:1024 lds
    buffer_load_dwordx4 v106, s[28:31], s55 offen offset:2048 lds
    buffer_load_dwordx4 v107, s[28:31], s55 offen offset:3072 lds
    s_add_u32 s55, s55, 131072
    s_cmp_ge_u32 s55, 3670016
    s_cselect_b32 s78, 3670016, 0
    s_sub_u32 s55, s55, s78
    s_add_u32 m0, s98, 147456
    s_nop 0
    buffer_load_dwordx4 v104, s[28:31], s55 offen offset:0 lds
    buffer_load_dwordx4 v105, s[28:31], s55 offen offset:1024 lds
    buffer_load_dwordx4 v106, s[28:31], s55 offen offset:2048 lds
    buffer_load_dwordx4 v107, s[28:31], s55 offen offset:3072 lds
    s_add_u32 s55, s55, 131072
    s_cmp_ge_u32 s55, 3670016
    s_cselect_b32 s78, 3670016, 0
    s_sub_u32 s55, s55, s78
    s_add_u32 m0, s98, 16384
    s_nop 0
    buffer_load_dwordx4 v104, s[28:31], s55 offen offset:0 lds
    buffer_load_dwordx4 v105, s[28:31], s55 offen offset:1024 lds
    buffer_load_dwordx4 v106, s[28:31], s55 offen offset:2048 lds
    buffer_load_dwordx4 v107, s[28:31], s55 offen offset:3072 lds
    s_add_u32 s55, s55, 131072
    s_cmp_ge_u32 s55, 3670016
    s_cselect_b32 s78, 3670016, 0
    s_sub_u32 s55, s55, s78
    s_mov_b32 s70, 0x001f001f
    s_mov_b32 s71, 0x001f001f
L_f_hpoll:
    buffer_load_dword v10, v9, s[36:39], s73 offen sc1
    s_waitcnt vmcnt(0)
    v_cmp_ne_u32 vcc, s44, v10
    s_and_b64 s[74:75], vcc, s[70:71]
    s_cbranch_scc0 L_f_hok
    s_sleep 8
    s_add_u32 s101, s101, 1
    s_cmp_gt_u32 s101, 0x100000
    s_cbranch_scc1 L_p1_end
    s_branch L_f_hpoll
L_f_hok:
    s_add_u32 m0, s98, 98304
    s_nop 0
    buffer_load_dwordx4 v108, s[36:39], s97 offen offset:0 sc1 lds
    buffer_load_dwordx4 v108, s[36:39], s97 offen offset:1024 sc1 lds
    buffer_load_dwordx4 v108, s[36:39], s97 offen offset:2048 sc1 lds
    buffer_load_dwordx4 v108, s[36:39], s97 offen offset:3072 sc1 lds
    s_add_u32 s97, s97, 262144
    s_cmp_ge_u32 s97, 7340032
    s_cselect_b32 s78, 7340032, 0
    s_sub_u32 s97, s97, s78
    s_add_u32 m0, s98, 131072
    s_nop 0
    buffer_load_dwordx4 v108, s[36:39], s97 offen offset:0 sc1 lds
    buffer_load_dwordx4 v108, s[36:39], s97 offen offset:1024 sc1 lds
    buffer_load_dwordx4 v108, s[36:39], s97 offen offset:2048 sc1 lds
    buffer_load_dwordx4 v108, s[36:39], s97 offen offset:3072 sc1 lds
    s_add_u32 s97, s97, 262144
    s_cmp_ge_u32 s97, 7340032
    s_cselect_b32 s78, 7340032, 0
    s_sub_u32 s97, s97, s78
    s_add_u32 m0, s98, 0
    s_nop 0
    buffer_load_dwordx4 v108, s[36:39], s97 offen offset:0 sc1 lds
    buffer_load_dwordx4 v108, s[36:39], s97 offen offset:1024 sc1 lds
    buffer_load_dwordx4 v108, s[36:39], s97 offen offset:2048 sc1 lds
    buffer_load_dwordx4 v108, s[36:39], s97 offen offset:3072 sc1 lds
    s_add_u32 s97, s97, 262144
    s_cmp_ge_u32 s97, 7340032
    s_cselect_b32 s78, 7340032, 0
    s_sub_u32 s97, s97, s78
    s_add_u32 m0, s98, 32768
    s_nop 0
    buffer_load_dwordx4 v108, s[36:39], s97 offen offset:0 sc1 lds
    buffer_load_dwordx4 v108, s[36:39], s97 offen offset:1024 sc1 lds
    buffer_load_dwordx4 v108, s[36:39], s97 offen offset:2048 sc1 lds
    buffer_load_dwordx4 v108, s[36:39], s97 offen offset:3072 sc1 lds
    s_add_u32 s97, s97, 262144
    s_cmp_ge_u32 s97, 7340032
    s_cselect_b32 s78, 7340032, 0
    s_sub_u32 s97, s97, s78
    s_add_u32 m0, s98, 49152
    s_nop 0
    buffer_load_dwordx4 v104, s[28:31], s55 offen offset:0 lds
    buffer_load_dwordx4 v105, s[28:31], s55 offen offset:1024 lds
    buffer_load_dwordx4 v106, s[28:31], s55 offen offset:2048 lds
    buffer_load_dwordx4 v107, s[28:31], s55 offen offset:3072 lds
    s_add_u32 s55, s55, 131072
    s_cmp_ge_u32 s55, 3670016
    s_cselect_b32 s78, 3670016, 0
    s_sub_u32 s55, s55, s78
    s_add_u32 m0, s98, 65536
    s_nop 0
    buffer_load_dwordx4 v108, s[36:39], s97 offen offset:0 sc1 lds
    buffer_load_dwordx4 v108, s[36:39], s97 offen offset:1024 sc1 lds
    buffer_load_dwordx4 v108, s[36:39], s97 offen offset:2048 sc1 lds
    buffer_load_dwordx4 v108, s[36:39], s97 offen offset:3072 sc1 lds
    s_add_u32 s97, s97, 262144
    s_cmp_ge_u32 s97, 7340032
    s_cselect_b32 s78, 7340032, 0
    s_sub_u32 s97, s97, s78
    s_add_u32 m0, s98, 81920
    s_nop 0
    buffer_load_dwordx4 v104, s[28:31], s55 offen offset:0 lds
    buffer_load_dwordx4 v105, s[28:31], s55 offen offset:1024 lds
    buffer_load_dwordx4 v106, s[28:31], s55 offen offset:2048 lds
    buffer_load_dwordx4 v107, s[28:31], s55 offen offset:3072 lds
    s_add_u32 s55, s55, 131072
    s_cmp_ge_u32 s55, 3670016
    s_cselect_b32 s78, 3670016, 0
    s_sub_u32 s55, s55, s78
    buffer_load_dword v10, v9, s[36:39], s73 offen sc1
    s_waitcnt vmcnt(25)
    s_barrier
    s_waitcnt vmcnt(21)
    s_barrier
    s_add_u32 m0, s96, s98
    s_nop 0
    buffer_load_dwordx4 v108, s[36:39], s97 offen offset:0 sc1 lds
    buffer_load_dwordx4 v108, s[36:39], s97 offen offset:1024 sc1 lds
    buffer_load_dwordx4 v108, s[36:39], s97 offen offset:2048 sc1 lds
    buffer_load_dwordx4 v108, s[36:39], s97 offen offset:3072 sc1 lds
    s_add_u32 m0, m0, 16384
    s_nop 0
    buffer_load_dwordx4 v104, s[28:31], s55 offen offset:0 lds
    buffer_load_dwordx4 v105, s[28:31], s55 offen offset:1024 lds
    buffer_load_dwordx4 v106, s[28:31], s55 offen offset:2048 lds
    buffer_load_dwordx4 v107, s[28:31], s55 offen offset:3072 lds
    s_add_u32 s97, s97, 262144
    s_cmp_ge_u32 s97, 7340032
    s_cselect_b32 s78, 7340032, 0
    s_sub_u32 s97, s97, s78
    s_add_u32 s55, s55, 131072
    s_cmp_ge_u32 s55, 3670016
    s_cselect_b32 s78, 3670016, 0
    s_sub_u32 s55, s55, s78
    s_add_u32 s96, s96, 32768
    s_cmp_ge_u32 s96, 163840
    s_cselect_b32 s96, 0, s96
    s_waitcnt vmcnt(25)
    s_barrier
    s_add_u32 m0, s96, s98
    s_nop 0
    buffer_load_dwordx4 v108, s[36:39], s97 offen offset:0 sc1 lds
    buffer_load_dwordx4 v108, s[36:39], s97 offen offset:1024 sc1 lds
    buffer_load_dwordx4 v108, s[36:39], s97 offen offset:2048 sc1 lds
    buffer_load_dwordx4 v108, s[36:39], s97 offen offset:3072 sc1 lds
    s_add_u32 m0, m0, 16384
    s_nop 0
    buffer_load_dwordx4 v104, s[28:31], s55 offen offset:0 lds
    buffer_load_dwordx4 v105, s[28:31], s55 offen offset:1024 lds
    buffer_load_dwordx4 v106, s[28:31], s55 offen offset:2048 lds
    buffer_load_dwordx4 v107, s[28:31], s55 offen offset:3072 lds
    s_add_u32 s97, s97, 262144
    s_cmp_ge_u32 s97, 7340032
    s_cselect_b32 s78, 7340032, 0
    s_sub_u32 s97, s97, s78
    s_add_u32 s55, s55, 131072
    s_cmp_ge_u32 s55, 3670016
    s_cselect_b32 s78, 3670016, 0
    s_sub_u32 s55, s55, s78
    s_add_u32 s96, s96, 32768
    s_cmp_ge_u32 s96, 163840
    s_cselect_b32 s96, 0, s96
    s_waitcnt vmcnt(25)
    s_barrier
    s_add_u32 m0, s96, s98
    s_nop 0
    buffer_load_dwordx4 v108, s[36:39], s97 offen offset:0 sc1 lds
    buffer_load_dwordx4 v108, s[36:39], s97 offen offset:1024 sc1 lds
    buffer_load_dwordx4 v108, s[36:39], s97 offen offset:2048 sc1 lds
    buffer_load_dwordx4 v108, s[36:39], s97 offen offset:3072 sc1 lds
    s_add_u32 m0, m0, 16384
    s_nop 0
    buffer_load_dwordx4 v104, s[28:31], s55 offen offset:0 lds
    buffer_load_dwordx4 v105, s[28:31], s55 offen offset:1024 lds
    buffer_load_dwordx4 v106, s[28:31], s55 offen offset:2048 lds
    buffer_load_dwordx4 v107, s[28:31], s55 offen offset:3072 lds
    s_add_u32 s97, s97, 262144
    s_cmp_ge_u32 s97, 7340032
    s_cselect_b32 s78, 7340032, 0
    s_sub_u32 s97, s97, s78
    s_add_u32 s55, s55, 131072
    s_cmp_ge_u32 s55, 3670016
    s_cselect_b32 s78, 3670016, 0
    s_sub_u32 s55, s55, s78
    s_add_u32 s96, s96, 32768
    s_cmp_ge_u32 s96, 163840
    s_cselect_b32 s96, 0, s96
    s_waitcnt vmcnt(24)
    s_barrier
L_f_hp2:
    v_cmp_ne_u32 vcc, s44, v10
    s_cbranch_vccz L_f_hok2
    s_sleep 4
    s_add_u32 s101, s101, 1
    s_cmp_gt_u32 s101, 0x100000
    s_cbranch_scc1 L_p1_end
    buffer_load_dword v10, v9, s[36:39], s73 offen sc1
    s_waitcnt vmcnt(0)
    s_branch L_f_hp2
L_f_hok2:
    s_add_u32 m0, s96, s98
    s_nop 0
    buffer_load_dwordx4 v108, s[36:39], s97 offen offset:0 sc1 lds
    buffer_load_dwordx4 v108, s[36:39], s97 offen offset:1024 sc1 lds
    buffer_load_dwordx4 v108, s[36:39], s97 offen offset:2048 sc1 lds
    buffer_load_dwordx4 v108, s[36:39], s97 offen offset:3072 sc1 lds
    s_add_u32 m0, m0, 16384
    s_nop 0
    buffer_load_dwordx4 v104, s[28:31], s55 offen offset:0 lds
    buffer_load_dwordx4 v105, s[28:31], s55 offen offset:1024 lds
    buffer_load_dwordx4 v106, s[28:31], s55 offen offset:2048 lds
    buffer_load_dwordx4 v107, s[28:31], s55 offen offset:3072 lds
    s_add_u32 s97, s97, 262144
    s_cmp_ge_u32 s97, 7340032
    s_cselect_b32 s78, 7340032, 0
    s_sub_u32 s97, s97, s78
    s_add_u32 s55, s55, 131072
    s_cmp_ge_u32 s55, 3670016
    s_cselect_b32 s78, 3670016, 0
    s_sub_u32 s55, s55, s78
    s_add_u32 s96, s96, 32768
    s_cmp_ge_u32 s96, 163840
    s_cselect_b32 s96, 0, s96
    s_mov_b32 s52, 5
L_p2_lloop:
    s_waitcnt vmcnt(24)
    s_barrier
    s_add_u32 m0, s96, s98
    s_nop 0
    buffer_load_dwordx4 v108, s[36:39], s97 offen offset:0 sc1 lds
    buffer_load_dwordx4 v108, s[36:39], s97 offen offset:1024 sc1 lds
    buffer_load_dwordx4 v108, s[36:39], s97 offen offset:2048 sc1 lds
    buffer_load_dwordx4 v108, s[36:39], s97 offen offset:3072 sc1 lds
    s_add_u32 m0, m0, 16384
    s_nop 0
    buffer_load_dwordx4 v104, s[28:31], s55 offen offset:0 lds
    buffer_load_dwordx4 v105, s[28:31], s55 offen offset:1024 lds
    buffer_load_dwordx4 v106, s[28:31], s55 offen offset:2048 lds
    buffer_load_dwordx4 v107, s[28:31], s55 offen offset:3072 lds
    s_add_u32 s97, s97, 262144
    s_cmp_ge_u32 s97, 7340032
    s_cselect_b32 s78, 7340032, 0
    s_sub_u32 s97, s97, s78
    s_add_u32 s55, s55, 131072
    s_cmp_ge_u32 s55, 3670016
    s_cselect_b32 s78, 3670016, 0
    s_sub_u32 s55, s55, s78
    s_add_u32 s96, s96, 32768
    s_cmp_ge_u32 s96, 163840
    s_cselect_b32 s96, 0, s96
    s_add_u32 s52, s52, 1
    s_cmp_lt_u32 s52, 21
    s_cbranch_scc1 L_p2_lloop
    s_lshl_b32 s63, s49, 7
    s_lshl_b32 s64, s60, 5
    s_add_u32 s63, s63, s64
    v_and_b32 v4, 15, v2
    v_add_u32 v4, s63, v4
    v_lshrrev_b32 v5, 4, v2
    s_cmp_eq_u32 s51, 0
    s_cselect_b32 s64, s99, s100
    s_lshl_b32 s64, s64, 6
    v_lshlrev_b32 v6, 2, v4
    v_lshlrev_b32 v7, 15, v5
    s_cmp_ge_u32 s64, 512
    s_cbranch_scc1 L_p2_mir
    v_add_u32 v12, v6, v7
    v_add_u32 v13, 64, v12
    s_lshl_b32 s66, s64, 13
    s_mov_b32 s67, 8192
    s_branch L_p2_mird
L_p2_mir:
    v_sub_u32 v12, 0x800, v4
    v_subrev_u32 v13, 16, v12
    v_and_b32 v12, 0x7ff, v12
    v_lshlrev_b32 v12, 2, v12
    v_lshlrev_b32 v13, 2, v13
    v_sub_u32 v7, 0x18000, v7
    v_add_u32 v12, v12, v7
    v_add_u32 v13, v13, v7
    s_sub_u32 s66, 1012, s64
    s_lshl_b32 s66, s66, 13
    s_mov_b32 s67, -8192
L_p2_mird:
    s_add_u32 s66, s66, 0x01a00000
    s_sub_u32 s68, 961, s64
    s_cmp_ge_u32 s64, 512
    s_cselect_b32 s69, s68, s64
    s_lshl_b32 s69, s69, 2
    s_add_u32 s69, s69, 0x01914000
    v_lshlrev_b32 v9, 2, v2
    buffer_load_dword v10, v9, s[36:39], s69 offen sc1
    s_waitcnt vmcnt(25)
    s_barrier
    s_add_u32 m0, s96, s98
    s_nop 0
    buffer_load_dwordx4 v108, s[36:39], s97 offen offset:0 sc1 lds
    buffer_load_dwordx4 v108, s[36:39], s97 offen offset:1024 sc1 lds
    buffer_load_dwordx4 v108, s[36:39], s97 offen offset:2048 sc1 lds
    buffer_load_dwordx4 v108, s[36:39], s97 offen offset:3072 sc1 lds
    s_add_u32 m0, m0, 16384
    s_nop 0
    buffer_load_dwordx4 v104, s[28:31], s55 offen offset:0 lds
    buffer_load_dwordx4 v105, s[28:31], s55 offen offset:1024 lds
    buffer_load_dwordx4 v106, s[28:31], s55 offen offset:2048 lds
    buffer_load_dwordx4 v107, s[28:31], s55 offen offset:3072 lds
    s_add_u32 s97, s97, 262144
    s_cmp_ge_u32 s97, 7340032
    s_cselect_b32 s78, 7340032, 0
    s_sub_u32 s97, s97, s78
    s_add_u32 s55, s55, 131072
    s_cmp_ge_u32 s55, 3670016
    s_cselect_b32 s78, 3670016, 0
    s_sub_u32 s55, s55, s78
    s_add_u32 s96, s96, 32768
    s_cmp_ge_u32 s96, 163840
    s_cselect_b32 s96, 0, s96
    s_waitcnt vmcnt(25)
    s_barrier
    s_add_u32 m0, s96, s98
    s_nop 0
    buffer_load_dwordx4 v108, s[36:39], s97 offen offset:0 sc1 lds
    buffer_load_dwordx4 v108, s[36:39], s97 offen offset:1024 sc1 lds
    buffer_load_dwordx4 v108, s[36:39], s97 offen offset:2048 sc1 lds
    buffer_load_dwordx4 v108, s[36:39], s97 offen offset:3072 sc1 lds
    s_add_u32 m0, m0, 16384
    s_nop 0
    buffer_load_dwordx4 v104, s[28:31], s55 offen offset:0 lds
    buffer_load_dwordx4 v105, s[28:31], s55 offen offset:1024 lds
    buffer_load_dwordx4 v106, s[28:31], s55 offen offset:2048 lds
    buffer_load_dwordx4 v107, s[28:31], s55 offen offset:3072 lds
    s_add_u32 s97, s97, 262144
    s_cmp_ge_u32 s97, 7340032
    s_cselect_b32 s78, 7340032, 0
    s_sub_u32 s97, s97, s78
    s_add_u32 s55, s55, 131072
    s_cmp_ge_u32 s55, 3670016
    s_cselect_b32 s78, 3670016, 0
    s_sub_u32 s55, s55, s78
    s_add_u32 s96, s96, 32768
    s_cmp_ge_u32 s96, 163840
    s_cselect_b32 s96, 0, s96
    s_waitcnt vmcnt(25)
    s_barrier
    s_add_u32 m0, s96, s98
    s_nop 0
    buffer_load_dwordx4 v108, s[36:39], s97 offen offset:0 sc1 lds
    buffer_load_dwordx4 v108, s[36:39], s97 offen offset:1024 sc1 lds
    buffer_load_dwordx4 v108, s[36:39], s97 offen offset:2048 sc1 lds
    buffer_load_dwordx4 v108, s[36:39], s97 offen offset:3072 sc1 lds
    s_add_u32 m0, m0, 16384
    s_nop 0
    buffer_load_dwordx4 v104, s[28:31], s55 offen offset:0 lds
    buffer_load_dwordx4 v105, s[28:31], s55 offen offset:1024 lds
    buffer_load_dwordx4 v106, s[28:31], s55 offen offset:2048 lds
    buffer_load_dwordx4 v107, s[28:31], s55 offen offset:3072 lds
    s_add_u32 s97, s97, 262144
    s_cmp_ge_u32 s97, 7340032
    s_cselect_b32 s78, 7340032, 0
    s_sub_u32 s97, s97, s78
    s_add_u32 s55, s55, 131072
    s_cmp_ge_u32 s55, 3670016
    s_cselect_b32 s78, 3670016, 0
    s_sub_u32 s55, s55, s78
    s_add_u32 s96, s96, 32768
    s_cmp_ge_u32 s96, 163840
    s_cselect_b32 s96, 0, s96
    s_waitcnt vmcnt(24)
    s_barrier
L_p2_poll1:
    v_cmp_ne_u32 vcc, s44, v10
    s_cbranch_vccz L_p2_poll1d
    s_sleep 1
    s_add_u32 s101, s101, 1
    s_cmp_gt_u32 s101, 0x100000
    s_cbranch_scc1 L_p1_end
    buffer_load_dword v10, v9, s[36:39], s69 offen sc1
    s_waitcnt vmcnt(0)
    s_branch L_p2_poll1
L_p2_poll1d:
    s_mov_b32 s68, 0x01900000
    buffer_load_dword v14, v6, s[36:39], s68 offen sc1
    buffer_load_dword v15, v6, s[36:39], s68 offen offset:64 sc1
    v_mov_b32 v18, s44
    s_mul_i32 s68, s67, 0
    s_add_u32 s68, s68, s66
    buffer_load_dword v32, v12, s[36:39], s68 offen
    buffer_load_dword v48, v13, s[36:39], s68 offen
    s_mul_i32 s68, s67, 1
    s_add_u32 s68, s68, s66
    buffer_load_dword v33, v12, s[36:39], s68 offen
    buffer_load_dword v49, v13, s[36:39], s68 offen
    s_mul_i32 s68, s67, 2
    s_add_u32 s68, s68, s66
    buffer_load_dword v34, v12, s[36:39], s68 offen
    buffer_load_dword v50, v13, s[36:39], s68 offen
    s_mul_i32 s68, s67, 3
    s_add_u32 s68, s68, s66
    buffer_load_dword v35, v12, s[36:39], s68 offen
    buffer_load_dword v51, v13, s[36:39], s68 offen
    s_mul_i32 s68, s67, 16
    s_add_u32 s68, s68, s66
    buffer_load_dword v36, v12, s[36:39], s68 offen
    buffer_load_dword v52, v13, s[36:39], s68 offen
    s_mul_i32 s68, s67, 17
    s_add_u32 s68, s68, s66
    buffer_load_dword v37, v12, s[36:39], s68 offen
    buffer_load_dword v53, v13, s[36:39], s68 offen
    s_mul_i32 s68, s67, 18
    s_add_u32 s68, s68, s66
    buffer_load_dword v38, v12, s[36:39], s68 offen
    buffer_load_dword v54, v13, s[36:39], s68 offen
    s_mul_i32 s68, s67, 19
    s_add_u32 s68, s68, s66
    buffer_load_dword v39, v12, s[36:39], s68 offen
    buffer_load_dword v55, v13, s[36:39], s68 offen
    s_mul_i32 s68, s67, 32
    s_add_u32 s68, s68, s66
    buffer_load_dword v40, v12, s[36:39], s68 offen
    buffer_load_dword v56, v13, s[36:39], s68 offen
    s_mul_i32 s68, s67, 33
    s_add_u32 s68, s68, s66
    buffer_load_dword v41, v12, s[36:39], s68 offen
    buffer_load_dword v57, v13, s[36:39], s68 offen
    s_mul_i32 s68, s67, 34
    s_add_u32 s68, s68, s66
    buffer_load_dword v42, v12, s[36:39], s68 offen
    buffer_load_dword v58, v13, s[36:39], s68 offen
    s_mul_i32 s68, s67, 35
    s_add_u32 s68, s68, s66
    buffer_load_dword v43, v12, s[36:39], s68 offen
    buffer_load_dword v59, v13, s[36:39], s68 offen
    s_mul_i32 s68, s67, 48
    s_add_u32 s68, s68, s66
    buffer_load_dword v44, v12, s[36:39], s68 offen
    buffer_load_dword v60, v13, s[36:39], s68 offen
    s_mul_i32 s68, s67, 49
    s_add_u32 s68, s68, s66
    buffer_load_dword v45, v12, s[36:39], s68 offen
    buffer_load_dword v61, v13, s[36:39], s68 offen
    s_mul_i32 s68, s67, 50
    s_add_u32 s68, s68, s66
    buffer_load_dword v46, v12, s[36:39], s68 offen
    buffer_load_dword v62, v13, s[36:39], s68 offen
    s_mul_i32 s68, s67, 51
    s_add_u32 s68, s68, s66
    buffer_load_dword v47, v12, s[36:39], s68 offen
    buffer_load_dword v63, v13, s[36:39], s68 offen
    s_waitcnt vmcnt(50)
    s_barrier
    s_waitcnt vmcnt(42)
    s_barrier
    s_waitcnt vmcnt(34)
    s_barrier
    v_lshlrev_b32 v6, 11, v4
    v_and_b32 v7, 16, v2
    v_lshlrev_b32 v7, 1, v7
    v_add_u32 v6, v6, v7
    v_lshrrev_b32 v7, 5, v2
    v_lshlrev_b32 v7, 4, v7
    v_add_u32 v6, v6, v7
    s_lshl_b32 s64, s64, 1
    s_add_u32 s65, s64, 32768
    v_and_b32 v7, 8, v2
    v_mul_u32_u24 v7, 2040, v7
    v_sub_u32 v6, v6, v7
    s_add_u32 s70, s64, 16384
    s_add_u32 s71, s65, 16384
    s_lshl_b32 s62, s60, 13
    v_lshlrev_b32 v3, 4, v2
    v_add_u32 v3, s62, v3
    v_add_u32 v8, 4096, v3
    s_waitcnt vmcnt(0)
    v_mov_b32 v20, v15
    v_mov_b32 v21, v15
    v_mov_b32 v15, v14
    v_sub_f32 v16, 1.0, v14
    v_sub_f32 v22, 1.0, v20
    v_cvt_pk_bf16_f32 v16, v16, v16
    v_cvt_pk_bf16_f32 v22, v22, v22
    v_lshlrev_b32 v16, 16, v16
    v_lshlrev_b32 v22, 16, v22
    v_mov_b32 v17, v16
    v_mov_b32 v23, v22
    v_and_b32 v18, 0xfff, v18
    v_pk_mul_f32 v[32:33], v[32:33], v[14:15]
    v_pk_mul_f32 v[34:35], v[34:35], v[14:15]
    v_pk_mul_f32 v[36:37], v[36:37], v[14:15]
    v_pk_mul_f32 v[38:39], v[38:39], v[14:15]
    v_pk_mul_f32 v[40:41], v[40:41], v[14:15]
    v_pk_mul_f32 v[42:43], v[42:43], v[14:15]
    v_pk_mul_f32 v[44:45], v[44:45], v[14:15]
    v_pk_mul_f32 v[46:47], v[46:47], v[14:15]
    v_pk_mul_f32 v[48:49], v[48:49], v[20:21]
    v_pk_mul_f32 v[50:51], v[50:51], v[20:21]
    v_pk_mul_f32 v[52:53], v[52:53], v[20:21]
    v_pk_mul_f32 v[54:55], v[54:55], v[20:21]
    v_pk_mul_f32 v[56:57], v[56:57], v[20:21]
    v_pk_mul_f32 v[58:59], v[58:59], v[20:21]
    v_pk_mul_f32 v[60:61], v[60:61], v[20:21]
    v_pk_mul_f32 v[62:63], v[62:63], v[20:21]
    s_mul_i32 s66, s2, 32768
    s_add_u32 s66, s66, 0x01f00000
    v_mov_b32 v24, v3
    s_barrier
    ds_read_b128 v[64:67], v3 offset:32768
    ds_read_b128 v[68:71], v3 offset:33792
    ds_read_b128 v[72:75], v3 offset:34816
    ds_read_b128 v[76:79], v3 offset:35840
    ds_read_b128 v[80:83], v3 offset:36864
    ds_read_b128 v[84:87], v3 offset:37888
    ds_read_b128 v[88:91], v3 offset:38912
    ds_read_b128 v[92:95], v3 offset:39936
    buffer_load_dwordx4 v[96:99], v24, s[36:39], s66 offen offset:0 sc1
    buffer_load_dwordx4 v[100:103], v24, s[36:39], s66 offen offset:1024 sc1
    buffer_load_dwordx4 v[104:107], v24, s[36:39], s66 offen offset:2048 sc1
    buffer_load_dwordx4 v[108:111], v24, s[36:39], s66 offen offset:3072 sc1
    buffer_load_dwordx4 v[112:115], v8, s[36:39], s66 offen offset:0 sc1
    buffer_load_dwordx4 v[116:119], v8, s[36:39], s66 offen offset:1024 sc1
    buffer_load_dwordx4 v[120:123], v8, s[36:39], s66 offen offset:2048 sc1
    buffer_load_dwordx4 v[124:127], v8, s[36:39], s66 offen offset:3072 sc1
    s_waitcnt lgkmcnt(0)
    v_pk_fma_f32 v[32:33], v[64:65], v[16:17], v[32:33]
    v_pk_fma_f32 v[34:35], v[66:67], v[16:17], v[34:35]
    v_pk_fma_f32 v[36:37], v[68:69], v[16:17], v[36:37]
    v_pk_fma_f32 v[38:39], v[70:71], v[16:17], v[38:39]
    v_pk_fma_f32 v[40:41], v[72:73], v[16:17], v[40:41]
    v_pk_fma_f32 v[42:43], v[74:75], v[16:17], v[42:43]
    v_pk_fma_f32 v[44:45], v[76:77], v[16:17], v[44:45]
    v_pk_fma_f32 v[46:47], v[78:79], v[16:17], v[46:47]
    v_pk_fma_f32 v[48:49], v[80:81], v[22:23], v[48:49]
    v_pk_fma_f32 v[50:51], v[82:83], v[22:23], v[50:51]
    v_pk_fma_f32 v[52:53], v[84:85], v[22:23], v[52:53]
    v_pk_fma_f32 v[54:55], v[86:87], v[22:23], v[54:55]
    v_pk_fma_f32 v[56:57], v[88:89], v[22:23], v[56:57]
    v_pk_fma_f32 v[58:59], v[90:91], v[22:23], v[58:59]
    v_pk_fma_f32 v[60:61], v[92:93], v[22:23], v[60:61]
    v_pk_fma_f32 v[62:63], v[94:95], v[22:23], v[62:63]
L_p2_poll2:
    v_mov_b32 v19, 0
    s_waitcnt vmcnt(7)
    v_xor_b32 v96, v96, v18
    v_xor_b32 v97, v97, v18
    v_xor_b32 v98, v98, v18
    v_xor_b32 v99, v99, v18
    v_or3_b32 v19, v19, v96, v97
    v_or3_b32 v19, v19, v98, v99
    s_waitcnt vmcnt(6)
    v_xor_b32 v100, v100, v18
    v_xor_b32 v101, v101, v18
    v_xor_b32 v102, v102, v18
    v_xor_b32 v103, v103, v18
    v_or3_b32 v19, v19, v100, v101
    v_or3_b32 v19, v19, v102, v103
    s_waitcnt vmcnt(5)
    v_xor_b32 v104, v104, v18
    v_xor_b32 v105, v105, v18
    v_xor_b32 v106, v106, v18
    v_xor_b32 v107, v107, v18
    v_or3_b32 v19, v19, v104, v105
    v_or3_b32 v19, v19, v106, v107
    s_waitcnt vmcnt(4)
    v_xor_b32 v108, v108, v18
    v_xor_b32 v109, v109, v18
    v_xor_b32 v110, v110, v18
    v_xor_b32 v111, v111, v18
    v_or3_b32 v19, v19, v108, v109
    v_or3_b32 v19, v19, v110, v111
    s_waitcnt vmcnt(3)
    v_xor_b32 v112, v112, v18
    v_xor_b32 v113, v113, v18
    v_xor_b32 v114, v114, v18
    v_xor_b32 v115, v115, v18
    v_or3_b32 v19, v19, v112, v113
    v_or3_b32 v19, v19, v114, v115
    s_waitcnt vmcnt(2)
    v_xor_b32 v116, v116, v18
    v_xor_b32 v117, v117, v18
    v_xor_b32 v118, v118, v18
    v_xor_b32 v119, v119, v18
    v_or3_b32 v19, v19, v116, v117
    v_or3_b32 v19, v19, v118, v119
    s_waitcnt vmcnt(1)
    v_xor_b32 v120, v120, v18
    v_xor_b32 v121, v121, v18
    v_xor_b32 v122, v122, v18
    v_xor_b32 v123, v123, v18
    v_or3_b32 v19, v19, v120, v121
    v_or3_b32 v19, v19, v122, v123
    s_waitcnt vmcnt(0)
    v_xor_b32 v124, v124, v18
    v_xor_b32 v125, v125, v18
    v_xor_b32 v126, v126, v18
    v_xor_b32 v127, v127, v18
    v_or3_b32 v19, v19, v124, v125
    v_or3_b32 v19, v19, v126, v127
    v_and_b32 v19, 0xfff, v19
    v_cmp_ne_u32 vcc, 0, v19
    s_cbranch_vccz L_p2_got
L_p2_poll2a:
    s_sleep 2
    s_add_u32 s101, s101, 1
    s_cmp_gt_u32 s101, 0x100000
    s_cbranch_scc1 L_p1_end
    buffer_load_dword v19, v8, s[36:39], s66 offen offset:3072 sc1
    s_waitcnt vmcnt(0)
    v_xor_b32 v19, v19, v18
    v_and_b32 v19, 0xfff, v19
    v_cmp_ne_u32 vcc, 0, v19
    s_cbranch_vccnz L_p2_poll2a
    buffer_load_dwordx4 v[96:99], v24, s[36:39], s66 offen offset:0 sc1
    buffer_load_dwordx4 v[100:103], v24, s[36:39], s66 offen offset:1024 sc1
    buffer_load_dwordx4 v[104:107], v24, s[36:39], s66 offen offset:2048 sc1
    buffer_load_dwordx4 v[108:111], v24, s[36:39], s66 offen offset:3072 sc1
    buffer_load_dwordx4 v[112:115], v8, s[36:39], s66 offen offset:0 sc1
    buffer_load_dwordx4 v[116:119], v8, s[36:39], s66 offen offset:1024 sc1
    buffer_load_dwordx4 v[120:123], v8, s[36:39], s66 offen offset:2048 sc1
    buffer_load_dwordx4 v[124:127], v8, s[36:39], s66 offen offset:3072 sc1
    s_branch L_p2_poll2
L_p2_got:
    v_pk_fma_f32 v[32:33], v[96:97], v[16:17], v[32:33]
    v_pk_fma_f32 v[34:35], v[98:99], v[16:17], v[34:35]
    v_pk_fma_f32 v[36:37], v[100:101], v[16:17], v[36:37]
    v_pk_fma_f32 v[38:39], v[102:103], v[16:17], v[38:39]
    v_pk_fma_f32 v[40:41], v[104:105], v[16:17], v[40:41]
    v_pk_fma_f32 v[42:43], v[106:107], v[16:17], v[42:43]
    v_pk_fma_f32 v[44:45], v[108:109], v[16:17], v[44:45]
    v_pk_fma_f32 v[46:47], v[110:111], v[16:17], v[46:47]
    v_cvt_pk_bf16_f32 v128, v32, v33
    v_cvt_pk_bf16_f32 v129, v34, v35
    v_cvt_pk_bf16_f32 v130, v36, v37
    v_cvt_pk_bf16_f32 v131, v38, v39
    v_cvt_pk_bf16_f32 v132, v40, v41
    v_cvt_pk_bf16_f32 v133, v42, v43
    v_cvt_pk_bf16_f32 v134, v44, v45
    v_cvt_pk_bf16_f32 v135, v46, v47
    s_nop 1
    v_permlane16_swap_b32 v128, v130
    v_permlane16_swap_b32 v129, v131
    v_permlane16_swap_b32 v132, v134
    v_permlane16_swap_b32 v133, v135
    v_mov_b32 v144, v128
    v_mov_b32 v145, v129
    v_mov_b32 v146, v130
    v_mov_b32 v147, v131
    s_nop 0
    v_mov_b32_dpp v128, v132 row_ror:8 row_mask:0xf bank_mask:0xc
    v_mov_b32_dpp v129, v133 row_ror:8 row_mask:0xf bank_mask:0xc
    v_mov_b32_dpp v130, v134 row_ror:8 row_mask:0xf bank_mask:0xc
    v_mov_b32_dpp v131, v135 row_ror:8 row_mask:0xf bank_mask:0xc
    v_mov_b32_dpp v132, v144 row_ror:8 row_mask:0xf bank_mask:0x3
    v_mov_b32_dpp v133, v145 row_ror:8 row_mask:0xf bank_mask:0x3
    v_mov_b32_dpp v134, v146 row_ror:8 row_mask:0xf bank_mask:0x3
    v_mov_b32_dpp v135, v147 row_ror:8 row_mask:0xf bank_mask:0x3
    buffer_store_dwordx4 v[128:131], v6, s[24:27], s64 offen sc1
    buffer_store_dwordx4 v[132:135], v6, s[24:27], s70 offen sc1
    v_pk_fma_f32 v[48:49], v[112:113], v[22:23], v[48:49]
    v_pk_fma_f32 v[50:51], v[114:115], v[22:23], v[50:51]
    v_pk_fma_f32 v[52:53], v[116:117], v[22:23], v[52:53]
    v_pk_fma_f32 v[54:55], v[118:119], v[22:23], v[54:55]
    v_pk_fma_f32 v[56:57], v[120:121], v[22:23], v[56:57]
    v_pk_fma_f32 v[58:59], v[122:123], v[22:23], v[58:59]
    v_pk_fma_f32 v[60:61], v[124:125], v[22:23], v[60:61]
    v_pk_fma_f32 v[62:63], v[126:127], v[22:23], v[62:63]
    v_cvt_pk_bf16_f32 v136, v48, v49
    v_cvt_pk_bf16_f32 v137, v50, v51
    v_cvt_pk_bf16_f32 v138, v52, v53
    v_cvt_pk_bf16_f32 v139, v54, v55
    v_cvt_pk_bf16_f32 v140, v56, v57
    v_cvt_pk_bf16_f32 v141, v58, v59
    v_cvt_pk_bf16_f32 v142, v60, v61
    v_cvt_pk_bf16_f32 v143, v62, v63
    s_nop 1
    v_permlane16_swap_b32 v136, v138
    v_permlane16_swap_b32 v137, v139
    v_permlane16_swap_b32 v140, v142
    v_permlane16_swap_b32 v141, v143
    v_mov_b32 v144, v136
    v_mov_b32 v145, v137
    v_mov_b32 v146, v138
    v_mov_b32 v147, v139
    s_nop 0
    v_mov_b32_dpp v136, v140 row_ror:8 row_mask:0xf bank_mask:0xc
    v_mov_b32_dpp v137, v141 row_ror:8 row_mask:0xf bank_mask:0xc
    v_mov_b32_dpp v138, v142 row_ror:8 row_mask:0xf bank_mask:0xc
    v_mov_b32_dpp v139, v143 row_ror:8 row_mask:0xf bank_mask:0xc
    v_mov_b32_dpp v140, v144 row_ror:8 row_mask:0xf bank_mask:0x3
    v_mov_b32_dpp v141, v145 row_ror:8 row_mask:0xf bank_mask:0x3
    v_mov_b32_dpp v142, v146 row_ror:8 row_mask:0xf bank_mask:0x3
    v_mov_b32_dpp v143, v147 row_ror:8 row_mask:0xf bank_mask:0x3
    buffer_store_dwordx4 v[136:139], v6, s[24:27], s65 offen sc1
    buffer_store_dwordx4 v[140:143], v6, s[24:27], s71 offen sc1
    s_endpgm
L_p1_end:
    s_endpgm
.section .rodata,"a"
.p2align 6
.amdhsa_kernel gated_mix__spectral_fnet__geglu_ffn__prompt_kernel
  .amdhsa_next_free_vgpr 256
  .amdhsa_next_free_sgpr 102
  .amdhsa_accum_offset 256
  .amdhsa_group_segment_fixed_size 0
  .amdhsa_kernarg_size 104
  .amdhsa_user_sgpr_count 2
  .amdhsa_user_sgpr_kernarg_segment_ptr 1
  .amdhsa_system_sgpr_workgroup_id_x 1
.end_amdhsa_kernel
```
